```python
import torch

def _softmax(x, axis=-1):
    return torch.softmax(x, dim=axis)
def _gelu(x):
    return torch.nn.functional.gelu(x, approximate="tanh")
def _silu(x):
    return torch.nn.functional.silu(x)
def _sigmoid(x):
    return torch.sigmoid(x)
def _layernorm(x, axis=-1, eps=1e-5):
    m = x.mean(dim=axis, keepdim=True)
    v = x.var(dim=axis, keepdim=True, unbiased=False)
    return (x - m) / torch.sqrt(v + eps)
def _scatter_add(tgt, idx, src, axis=0):
    return tgt.clone().index_add_(axis, idx, src)
def _segment_sum(src, seg, n):
    out = torch.zeros((n,) + src.shape[1:], dtype=src.dtype)
    return out.index_add_(0, seg, src)
def _pad(x, pw):
    flat = tuple(v for pair in reversed(pw) for v in pair)
    return torch.nn.functional.pad(x, flat)

kernel_name = 'standalone__layernorm_linear__sampling'

def setup_inputs():

    _w = (lambda a: (lambda t: t.to(torch.bfloat16) if t.is_floating_point() else t)(torch.as_tensor(a)))
    B, S, D = 1024, 16, 448
    return {
        "x": _w((lambda *s: torch.randn(*s, dtype=torch.bfloat16) * 0.05)(B, S, D)),
        "g": _w((lambda *s: torch.randn(*s, dtype=torch.bfloat16) * 0.05)(D) + 1.0),
        "b": _w((lambda *s: torch.randn(*s, dtype=torch.bfloat16) * 0.4)(D)),
        "w": _w((lambda *s: torch.randn(*s, dtype=torch.bfloat16) * 0.05)(D, D)),
    }

def reference(x, g, b, w):
    return (_layernorm(x, axis=-1) * g + b) @ w
```

```asm
; @launch grid=(256,1,1) block=(512,1,1) lds=163840
.amdgcn_target "amdgcn-amd-amdhsa--gfx950"
.text
.globl standalone__layernorm_linear__sampling_kernel
.p2align 12
.fill 832, 4, 0xbf800000
.p2align 8
.type standalone__layernorm_linear__sampling_kernel,@function
standalone__layernorm_linear__sampling_kernel:
    s_load_dwordx8 s[4:11], s[0:1], 0
    s_cmpk_ge_u32 s2, 0x100
    s_cbranch_scc1 L_end
    s_lshl_b32 s48, s2, 25
    s_lshr_b32 s38, s48, 18
    v_lshrrev_b32 v113, 3, v0
    v_add_u32 v113, s38, v113
    v_mul_u32_u24 v113, 896, v113
    v_and_b32 v114, 7, v0
    v_lshl_add_u32 v240, v114, 4, v113
    v_and_b32 v112, 63, v0
    v_min_u32 v115, 55, v112
    v_lshlrev_b32 v115, 4, v115
    s_waitcnt lgkmcnt(0)
    global_load_dwordx4 v[168:171], v240, s[4:5] offset:0 nt
    global_load_dwordx4 v[172:175], v240, s[4:5] offset:128 nt
    global_load_dwordx4 v[176:179], v240, s[4:5] offset:256 nt
    global_load_dwordx4 v[224:227], v115, s[6:7]
    global_load_dwordx4 v[228:231], v115, s[8:9]
    global_load_dwordx4 v[180:183], v240, s[4:5] offset:384 nt
    global_load_dwordx4 v[184:187], v240, s[4:5] offset:512 nt
    global_load_dwordx4 v[188:191], v240, s[4:5] offset:640 nt
    global_load_dwordx4 v[192:195], v240, s[4:5] offset:768 nt
    s_load_dwordx2 s[12:13], s[0:1], 32
    v_lshrrev_b32 v113, 6, v0
    s_add_u32 s16, s4, 57344
    s_addc_u32 s17, s5, 0
    v_readfirstlane_b32 s36, v113
    v_lshrrev_b32 v113, 3, v112
    v_mul_u32_u24 v116, 896, v113
    v_lshlrev_b32 v115, 4, v112
    s_and_b32 s37, s36, 3
    s_lshl_b32 s48, s36, 3
    s_add_u32 s48, s48, s38
    s_mul_i32 s41, s48, 896
    s_lshl_b32 s48, s37, 5
    s_add_u32 s48, s48, s38
    s_mul_i32 s38, s48, 896
    s_waitcnt lgkmcnt(0)
    s_cmp_ge_u32 s36, 4
    s_cbranch_scc1 L_helper
    s_mov_b32 s20, s10
    s_and_b32 s21, s11, 0xffff
    s_mov_b32 s22, 401408
    s_mov_b32 s23, 0x20000
    s_mov_b32 s24, s12
    s_and_b32 s25, s13, 0xffff
    s_mov_b32 s26, 14680064
    s_mov_b32 s27, 0x20000
    s_bitcmp1_b32 s2, 7
    s_cselect_b32 s39, 512, 0
    s_cselect_b32 s40, 64, 0
    s_add_u32 s40, s40, 384
    s_mul_i32 s50, s37, 7168
    s_add_u32 s50, s50, s39
    s_mul_i32 s51, s37, 14336
    s_add_u32 s51, s51, s40
    s_lshl_b32 s52, s37, 10
    s_mov_b32 s45, 0x00003f80
    s_mov_b32 s46, 0x3f800000
    s_mov_b32 s47, 0xffff0000
    s_add_u32 s53, s38, s39
    s_add_u32 s54, s38, s40
    s_lshl_b32 s43, s37, 12
    s_add_u32 s43, s43, 49152
    v_lshlrev_b32 v246, 6, v112
    v_bfe_u32 v113, v112, 4, 2
    v_bfe_u32 v114, v112, 0, 3
    v_xor_b32 v113, v113, v114
    s_lshl_b32 s49, s36, 2
    s_and_b32 s49, s49, 4
    v_xor_b32 v113, s49, v113
    v_lshlrev_b32 v241, 4, v113
    v_bfe_u32 v113, v112, 3, 3
    v_lshl_add_u32 v241, v113, 7, v241
    s_lshl_b32 s49, s36, 10
    s_add_u32 s49, s49, 49152
    v_add_u32 v241, s49, v241
    s_add_u32 s49, s49, 8192
    v_lshl_add_u32 v242, v114, 4, s49
    v_add_u32 v115, s49, v115
    v_bfe_u32 v113, v112, 2, 4
    v_bfe_u32 v114, v112, 0, 2
    v_mul_u32_u24 v253, 896, v113
    v_lshl_add_u32 v255, v114, 4, v253
    v_bfe_u32 v117, v112, 3, 2
    v_xor_b32 v117, v117, v114
    v_lshlrev_b32 v117, 4, v117
    s_lshl_b32 s49, s37, 11
    s_add_u32 s49, s49, 114688
    v_lshl_add_u32 v254, v113, 6, v117
    v_add_u32 v254, s49, v254
    v_bfe_u32 v113, v112, 1, 2
    v_bfe_u32 v114, v112, 4, 1
    v_xor_b32 v113, v113, v114
    s_and_b32 s49, s37, 1
    s_lshl_b32 s49, s49, 1
    v_xor_b32 v113, s49, v113
    v_lshl_add_u32 v243, v113, 5, v116
    v_bfe_u32 v113, v112, 0, 1
    v_lshl_add_u32 v243, v113, 4, v243
    s_add_u32 s48, s43, 81920
    v_bfe_u32 v113, v112, 3, 3
    v_bfe_u32 v114, v112, 0, 3
    v_xor_b32 v114, v114, v113
    v_lshlrev_b32 v114, 4, v114
    v_lshl_add_u32 v254, v113, 7, v114
    v_add_u32 v254, s48, v254
    s_and_b32 s48, s37, 1
    s_lshr_b32 s49, s37, 1
    v_bfe_u32 v113, v112, 4, 2
    v_bfe_u32 v114, v112, 2, 2
    v_bfe_u32 v116, v112, 0, 2
    v_lshlrev_b32 v253, 10, v113
    v_lshl_add_u32 v253, v114, 7, v253
    v_lshl_add_u32 v253, v116, 3, v253
    v_lshlrev_b32 v247, 9, v113
    v_lshl_add_u32 v247, v114, 6, v247
    v_lshl_add_u32 v247, v116, 3, v247
    v_bfe_u32 v114, v112, 3, 2
    s_lshl_b32 s44, s48, 1
    v_xor_b32 v114, s44, v114
    v_lshl_add_u32 v253, v114, 5, v253
    v_xor_b32 v244, 32, v253
    v_add_u32 v245, 0x10000, v253
    v_add_u32 v246, 0x10000, v244
    v_bfe_u32 v114, v112, 4, 1
    v_xor_b32 v114, s48, v114
    v_lshl_add_u32 v247, v114, 5, v247
    v_bfe_u32 v116, v112, 0, 4
    v_bfe_u32 v114, v112, 1, 3
    v_xor_b32 v114, v114, v113
    v_lshlrev_b32 v114, 4, v114
    v_lshl_add_u32 v248, v116, 7, v114
    s_lshl_b32 s55, s49, 13
    s_add_u32 s59, s55, 49152
    v_add_u32 v248, s59, v248
    v_xor_b32 v249, 64, v248
    v_bfe_u32 v114, v112, 5, 1
    s_lshl_b32 s44, s48, 2
    v_xor_b32 v117, s44, v114
    v_bfe_u32 v113, v112, 0, 3
    v_xor_b32 v117, v117, v113
    v_lshlrev_b32 v250, 4, v117
    v_lshl_add_u32 v250, v116, 7, v250
    v_bfe_u32 v117, v112, 4, 1
    v_lshl_add_u32 v250, v117, 3, v250
    s_add_u32 s59, s55, 131072
    v_add_u32 v250, s59, v250
    v_xor_b32 v251, 32, v250
    s_lshl_b32 s44, s48, 1
    v_xor_b32 v114, s44, v114
    v_bfe_u32 v113, v112, 1, 2
    v_xor_b32 v114, v114, v113
    v_lshlrev_b32 v252, 4, v114
    v_lshl_add_u32 v252, v116, 6, v252
    v_lshl_add_u32 v252, v117, 3, v252
    s_lshr_b32 s55, s55, 1
    s_add_u32 s59, s55, 114688
    v_add_u32 v252, s59, v252
    s_waitcnt vmcnt(4)
    v_lshlrev_b32 v0, 16, v224
    v_and_b32 v1, s47, v224
    v_lshlrev_b32 v2, 16, v225
    v_and_b32 v3, s47, v225
    v_lshlrev_b32 v4, 16, v226
    v_and_b32 v5, s47, v226
    v_lshlrev_b32 v6, 16, v227
    v_and_b32 v7, s47, v227
    v_lshlrev_b32 v8, 16, v228
    v_and_b32 v9, s47, v228
    v_lshlrev_b32 v10, 16, v229
    v_and_b32 v11, s47, v229
    v_lshlrev_b32 v12, 16, v230
    v_and_b32 v13, s47, v230
    v_lshlrev_b32 v14, 16, v231
    v_and_b32 v15, s47, v231
    ds_write_b128 v115, v[0:3] offset:0
    ds_write_b128 v115, v[4:7] offset:16384
    ds_write_b128 v115, v[8:11] offset:32768
    ds_write_b128 v115, v[12:15] offset:49152
    v_lshlrev_b32 v236, 16, v168
    s_nop 1
    v_mov_b32_dpp v238, v236 quad_perm:[0,0,0,0] row_mask:0xf bank_mask:0xf
    s_nop 1
    v_mov_b32_dpp v238, v238 row_shr:4 row_mask:0xf bank_mask:0xa
    global_load_dwordx4 v[196:199], v240, s[16:17] offset:0 nt
    v_dot2_f32_bf16 v112, v168, s45, v238 neg_lo:[0,0,1]
    v_dot2_f32_bf16 v113, v168, s46, v238 neg_lo:[0,0,1]
    v_dot2_f32_bf16 v114, v169, s45, v238 neg_lo:[0,0,1]
    v_dot2_f32_bf16 v115, v169, s46, v238 neg_lo:[0,0,1]
    v_dot2_f32_bf16 v116, v170, s45, v238 neg_lo:[0,0,1]
    v_dot2_f32_bf16 v117, v170, s46, v238 neg_lo:[0,0,1]
    v_dot2_f32_bf16 v118, v171, s45, v238 neg_lo:[0,0,1]
    v_dot2_f32_bf16 v119, v171, s46, v238 neg_lo:[0,0,1]
    v_pk_add_f32 v[232:233], v[112:113], v[114:115]
    v_pk_mul_f32 v[234:235], v[112:113], v[112:113]
    v_pk_fma_f32 v[234:235], v[114:115], v[114:115], v[234:235]
    v_pk_add_f32 v[232:233], v[232:233], v[116:117]
    v_pk_fma_f32 v[234:235], v[116:117], v[116:117], v[234:235]
    v_pk_add_f32 v[232:233], v[232:233], v[118:119]
    v_pk_fma_f32 v[234:235], v[118:119], v[118:119], v[234:235]
    ds_read_b128 v[0:3], v242 offset:0
    ds_read_b128 v[4:7], v242 offset:16384
    ds_read_b128 v[8:11], v242 offset:32768
    ds_read_b128 v[12:15], v242 offset:49152
    global_load_dwordx4 v[200:203], v240, s[16:17] offset:128 nt
    v_dot2_f32_bf16 v120, v172, s45, v238 neg_lo:[0,0,1]
    v_dot2_f32_bf16 v121, v172, s46, v238 neg_lo:[0,0,1]
    v_dot2_f32_bf16 v122, v173, s45, v238 neg_lo:[0,0,1]
    v_dot2_f32_bf16 v123, v173, s46, v238 neg_lo:[0,0,1]
    v_dot2_f32_bf16 v124, v174, s45, v238 neg_lo:[0,0,1]
    v_dot2_f32_bf16 v125, v174, s46, v238 neg_lo:[0,0,1]
    v_dot2_f32_bf16 v126, v175, s45, v238 neg_lo:[0,0,1]
    v_dot2_f32_bf16 v127, v175, s46, v238 neg_lo:[0,0,1]
    v_pk_add_f32 v[232:233], v[232:233], v[120:121]
    v_pk_fma_f32 v[234:235], v[120:121], v[120:121], v[234:235]
    v_pk_add_f32 v[232:233], v[232:233], v[122:123]
    v_pk_fma_f32 v[234:235], v[122:123], v[122:123], v[234:235]
    v_pk_add_f32 v[232:233], v[232:233], v[124:125]
    v_pk_fma_f32 v[234:235], v[124:125], v[124:125], v[234:235]
    v_pk_add_f32 v[232:233], v[232:233], v[126:127]
    v_pk_fma_f32 v[234:235], v[126:127], v[126:127], v[234:235]
    ds_read_b128 v[16:19], v242 offset:128
    ds_read_b128 v[20:23], v242 offset:16512
    ds_read_b128 v[24:27], v242 offset:32896
    ds_read_b128 v[28:31], v242 offset:49280
    global_load_dwordx4 v[204:207], v240, s[16:17] offset:256 nt
    v_dot2_f32_bf16 v128, v176, s45, v238 neg_lo:[0,0,1]
    v_dot2_f32_bf16 v129, v176, s46, v238 neg_lo:[0,0,1]
    v_dot2_f32_bf16 v130, v177, s45, v238 neg_lo:[0,0,1]
    v_dot2_f32_bf16 v131, v177, s46, v238 neg_lo:[0,0,1]
    v_dot2_f32_bf16 v132, v178, s45, v238 neg_lo:[0,0,1]
    v_dot2_f32_bf16 v133, v178, s46, v238 neg_lo:[0,0,1]
    v_dot2_f32_bf16 v134, v179, s45, v238 neg_lo:[0,0,1]
    v_dot2_f32_bf16 v135, v179, s46, v238 neg_lo:[0,0,1]
    v_pk_add_f32 v[232:233], v[232:233], v[128:129]
    v_pk_fma_f32 v[234:235], v[128:129], v[128:129], v[234:235]
    v_pk_add_f32 v[232:233], v[232:233], v[130:131]
    v_pk_fma_f32 v[234:235], v[130:131], v[130:131], v[234:235]
    v_pk_add_f32 v[232:233], v[232:233], v[132:133]
    v_pk_fma_f32 v[234:235], v[132:133], v[132:133], v[234:235]
    v_pk_add_f32 v[232:233], v[232:233], v[134:135]
    v_pk_fma_f32 v[234:235], v[134:135], v[134:135], v[234:235]
    ds_read_b128 v[32:35], v242 offset:256
    ds_read_b128 v[36:39], v242 offset:16640
    ds_read_b128 v[40:43], v242 offset:33024
    ds_read_b128 v[44:47], v242 offset:49408
    s_waitcnt vmcnt(6)
    global_load_dwordx4 v[208:211], v240, s[16:17] offset:384 nt
    v_dot2_f32_bf16 v136, v180, s45, v238 neg_lo:[0,0,1]
    v_dot2_f32_bf16 v137, v180, s46, v238 neg_lo:[0,0,1]
    v_dot2_f32_bf16 v138, v181, s45, v238 neg_lo:[0,0,1]
    v_dot2_f32_bf16 v139, v181, s46, v238 neg_lo:[0,0,1]
    v_dot2_f32_bf16 v140, v182, s45, v238 neg_lo:[0,0,1]
    v_dot2_f32_bf16 v141, v182, s46, v238 neg_lo:[0,0,1]
    v_dot2_f32_bf16 v142, v183, s45, v238 neg_lo:[0,0,1]
    v_dot2_f32_bf16 v143, v183, s46, v238 neg_lo:[0,0,1]
    v_pk_add_f32 v[232:233], v[232:233], v[136:137]
    v_pk_fma_f32 v[234:235], v[136:137], v[136:137], v[234:235]
    v_pk_add_f32 v[232:233], v[232:233], v[138:139]
    v_pk_fma_f32 v[234:235], v[138:139], v[138:139], v[234:235]
    v_pk_add_f32 v[232:233], v[232:233], v[140:141]
    v_pk_fma_f32 v[234:235], v[140:141], v[140:141], v[234:235]
    v_pk_add_f32 v[232:233], v[232:233], v[142:143]
    v_pk_fma_f32 v[234:235], v[142:143], v[142:143], v[234:235]
    ds_read_b128 v[48:51], v242 offset:384
    ds_read_b128 v[52:55], v242 offset:16768
    ds_read_b128 v[56:59], v242 offset:33152
    ds_read_b128 v[60:63], v242 offset:49536
    s_waitcnt vmcnt(6)
    global_load_dwordx4 v[212:215], v240, s[16:17] offset:512 nt
    v_dot2_f32_bf16 v144, v184, s45, v238 neg_lo:[0,0,1]
    v_dot2_f32_bf16 v145, v184, s46, v238 neg_lo:[0,0,1]
    v_dot2_f32_bf16 v146, v185, s45, v238 neg_lo:[0,0,1]
    v_dot2_f32_bf16 v147, v185, s46, v238 neg_lo:[0,0,1]
    v_dot2_f32_bf16 v148, v186, s45, v238 neg_lo:[0,0,1]
    v_dot2_f32_bf16 v149, v186, s46, v238 neg_lo:[0,0,1]
    v_dot2_f32_bf16 v150, v187, s45, v238 neg_lo:[0,0,1]
    v_dot2_f32_bf16 v151, v187, s46, v238 neg_lo:[0,0,1]
    v_pk_add_f32 v[232:233], v[232:233], v[144:145]
    v_pk_fma_f32 v[234:235], v[144:145], v[144:145], v[234:235]
    v_pk_add_f32 v[232:233], v[232:233], v[146:147]
    v_pk_fma_f32 v[234:235], v[146:147], v[146:147], v[234:235]
    v_pk_add_f32 v[232:233], v[232:233], v[148:149]
    v_pk_fma_f32 v[234:235], v[148:149], v[148:149], v[234:235]
    v_pk_add_f32 v[232:233], v[232:233], v[150:151]
    v_pk_fma_f32 v[234:235], v[150:151], v[150:151], v[234:235]
    ds_read_b128 v[64:67], v242 offset:512
    ds_read_b128 v[68:71], v242 offset:16896
    ds_read_b128 v[72:75], v242 offset:33280
    ds_read_b128 v[76:79], v242 offset:49664
    s_waitcnt vmcnt(6)
    global_load_dwordx4 v[216:219], v240, s[16:17] offset:640 nt
    v_dot2_f32_bf16 v152, v188, s45, v238 neg_lo:[0,0,1]
    v_dot2_f32_bf16 v153, v188, s46, v238 neg_lo:[0,0,1]
    v_dot2_f32_bf16 v154, v189, s45, v238 neg_lo:[0,0,1]
    v_dot2_f32_bf16 v155, v189, s46, v238 neg_lo:[0,0,1]
    v_dot2_f32_bf16 v156, v190, s45, v238 neg_lo:[0,0,1]
    v_dot2_f32_bf16 v157, v190, s46, v238 neg_lo:[0,0,1]
    v_dot2_f32_bf16 v158, v191, s45, v238 neg_lo:[0,0,1]
    v_dot2_f32_bf16 v159, v191, s46, v238 neg_lo:[0,0,1]
    v_pk_add_f32 v[232:233], v[232:233], v[152:153]
    v_pk_fma_f32 v[234:235], v[152:153], v[152:153], v[234:235]
    v_pk_add_f32 v[232:233], v[232:233], v[154:155]
    v_pk_fma_f32 v[234:235], v[154:155], v[154:155], v[234:235]
    v_pk_add_f32 v[232:233], v[232:233], v[156:157]
    v_pk_fma_f32 v[234:235], v[156:157], v[156:157], v[234:235]
    v_pk_add_f32 v[232:233], v[232:233], v[158:159]
    v_pk_fma_f32 v[234:235], v[158:159], v[158:159], v[234:235]
    ds_read_b128 v[80:83], v242 offset:640
    ds_read_b128 v[84:87], v242 offset:17024
    ds_read_b128 v[88:91], v242 offset:33408
    ds_read_b128 v[92:95], v242 offset:49792
    s_waitcnt vmcnt(6)
    global_load_dwordx4 v[220:223], v240, s[16:17] offset:768 nt
    v_dot2_f32_bf16 v160, v192, s45, v238 neg_lo:[0,0,1]
    v_dot2_f32_bf16 v161, v192, s46, v238 neg_lo:[0,0,1]
    v_dot2_f32_bf16 v162, v193, s45, v238 neg_lo:[0,0,1]
    v_dot2_f32_bf16 v163, v193, s46, v238 neg_lo:[0,0,1]
    v_dot2_f32_bf16 v164, v194, s45, v238 neg_lo:[0,0,1]
    v_dot2_f32_bf16 v165, v194, s46, v238 neg_lo:[0,0,1]
    v_dot2_f32_bf16 v166, v195, s45, v238 neg_lo:[0,0,1]
    v_dot2_f32_bf16 v167, v195, s46, v238 neg_lo:[0,0,1]
    v_pk_add_f32 v[232:233], v[232:233], v[160:161]
    v_pk_fma_f32 v[234:235], v[160:161], v[160:161], v[234:235]
    v_pk_add_f32 v[232:233], v[232:233], v[162:163]
    v_pk_fma_f32 v[234:235], v[162:163], v[162:163], v[234:235]
    v_pk_add_f32 v[232:233], v[232:233], v[164:165]
    v_pk_fma_f32 v[234:235], v[164:165], v[164:165], v[234:235]
    v_pk_add_f32 v[232:233], v[232:233], v[166:167]
    v_pk_fma_f32 v[234:235], v[166:167], v[166:167], v[234:235]
    ds_read_b128 v[96:99], v242 offset:768
    ds_read_b128 v[100:103], v242 offset:17152
    ds_read_b128 v[104:107], v242 offset:33536
    ds_read_b128 v[108:111], v242 offset:49920
    v_add_f32 v232, v232, v233
    v_add_f32 v234, v234, v235
    v_add_u32 v242, 0x10000, v241
    v_add_f32_dpp v232, v232, v232 quad_perm:[1,0,3,2] row_mask:0xf bank_mask:0xf
    v_add_f32_dpp v234, v234, v234 quad_perm:[1,0,3,2] row_mask:0xf bank_mask:0xf
    s_nop 0
    v_add_f32_dpp v232, v232, v232 quad_perm:[2,3,0,1] row_mask:0xf bank_mask:0xf
    v_add_f32_dpp v234, v234, v234 quad_perm:[2,3,0,1] row_mask:0xf bank_mask:0xf
    s_nop 0
    v_add_f32_dpp v232, v232, v232 row_half_mirror row_mask:0xf bank_mask:0xf
    v_add_f32_dpp v234, v234, v234 row_half_mirror row_mask:0xf bank_mask:0xf
    v_mul_f32 v232, 0x3b124925, v232
    v_mul_f32 v234, 0x3b124925, v234
    v_fma_f32 v234, -v232, v232, v234
    v_add_f32 v232, v232, v238
    v_cvt_pk_bf16_f32 v234, 0, v234
    v_cvt_pk_bf16_f32 v232, 0, v232
    v_add_f32 v234, 0x3727c5ac, v234
    v_cvt_pk_bf16_f32 v234, 0, v234
    v_sqrt_f32 v234, v234
    v_sub_f32 v232, v238, v232
    v_cvt_pk_bf16_f32 v234, 0, v234
    v_rcp_f32 v236, v234
    s_nop 0
    v_mul_f32 v237, v232, v236
    v_pk_fma_f32 v[112:113], v[112:113], v[236:237], v[236:237] op_sel:[0,0,1] op_sel_hi:[1,0,1]
    v_pk_fma_f32 v[114:115], v[114:115], v[236:237], v[236:237] op_sel:[0,0,1] op_sel_hi:[1,0,1]
    v_pk_fma_f32 v[116:117], v[116:117], v[236:237], v[236:237] op_sel:[0,0,1] op_sel_hi:[1,0,1]
    v_pk_fma_f32 v[118:119], v[118:119], v[236:237], v[236:237] op_sel:[0,0,1] op_sel_hi:[1,0,1]
    s_waitcnt lgkmcnt(15)
    v_pk_fma_f32 v[112:113], v[112:113], v[0:1], v[8:9]
    v_pk_fma_f32 v[114:115], v[114:115], v[2:3], v[10:11]
    v_pk_fma_f32 v[116:117], v[116:117], v[4:5], v[12:13]
    v_pk_fma_f32 v[118:119], v[118:119], v[6:7], v[14:15]
    v_cvt_pk_bf16_f32 v224, v112, v113
    v_cvt_pk_bf16_f32 v225, v114, v115
    v_cvt_pk_bf16_f32 v226, v116, v117
    v_cvt_pk_bf16_f32 v227, v118, v119
    v_pk_fma_f32 v[120:121], v[120:121], v[236:237], v[236:237] op_sel:[0,0,1] op_sel_hi:[1,0,1]
    v_pk_fma_f32 v[122:123], v[122:123], v[236:237], v[236:237] op_sel:[0,0,1] op_sel_hi:[1,0,1]
    v_pk_fma_f32 v[124:125], v[124:125], v[236:237], v[236:237] op_sel:[0,0,1] op_sel_hi:[1,0,1]
    v_pk_fma_f32 v[126:127], v[126:127], v[236:237], v[236:237] op_sel:[0,0,1] op_sel_hi:[1,0,1]
    ds_write_b128 v241, v[224:227] offset:0
    s_waitcnt lgkmcnt(15)
    v_pk_fma_f32 v[120:121], v[120:121], v[16:17], v[24:25]
    v_pk_fma_f32 v[122:123], v[122:123], v[18:19], v[26:27]
    v_pk_fma_f32 v[124:125], v[124:125], v[20:21], v[28:29]
    v_pk_fma_f32 v[126:127], v[126:127], v[22:23], v[30:31]
    v_cvt_pk_bf16_f32 v228, v120, v121
    v_cvt_pk_bf16_f32 v229, v122, v123
    v_cvt_pk_bf16_f32 v230, v124, v125
    v_cvt_pk_bf16_f32 v231, v126, v127
    v_pk_fma_f32 v[128:129], v[128:129], v[236:237], v[236:237] op_sel:[0,0,1] op_sel_hi:[1,0,1]
    v_pk_fma_f32 v[130:131], v[130:131], v[236:237], v[236:237] op_sel:[0,0,1] op_sel_hi:[1,0,1]
    v_pk_fma_f32 v[132:133], v[132:133], v[236:237], v[236:237] op_sel:[0,0,1] op_sel_hi:[1,0,1]
    v_pk_fma_f32 v[134:135], v[134:135], v[236:237], v[236:237] op_sel:[0,0,1] op_sel_hi:[1,0,1]
    ds_write_b128 v241, v[228:231] offset:16384
    s_waitcnt lgkmcnt(15)
    v_pk_fma_f32 v[128:129], v[128:129], v[32:33], v[40:41]
    v_pk_fma_f32 v[130:131], v[130:131], v[34:35], v[42:43]
    v_pk_fma_f32 v[132:133], v[132:133], v[36:37], v[44:45]
    v_pk_fma_f32 v[134:135], v[134:135], v[38:39], v[46:47]
    v_cvt_pk_bf16_f32 v224, v128, v129
    v_cvt_pk_bf16_f32 v225, v130, v131
    v_cvt_pk_bf16_f32 v226, v132, v133
    v_cvt_pk_bf16_f32 v227, v134, v135
    v_pk_fma_f32 v[136:137], v[136:137], v[236:237], v[236:237] op_sel:[0,0,1] op_sel_hi:[1,0,1]
    v_pk_fma_f32 v[138:139], v[138:139], v[236:237], v[236:237] op_sel:[0,0,1] op_sel_hi:[1,0,1]
    v_pk_fma_f32 v[140:141], v[140:141], v[236:237], v[236:237] op_sel:[0,0,1] op_sel_hi:[1,0,1]
    v_pk_fma_f32 v[142:143], v[142:143], v[236:237], v[236:237] op_sel:[0,0,1] op_sel_hi:[1,0,1]
    ds_write_b128 v241, v[224:227] offset:32768
    s_waitcnt lgkmcnt(15)
    v_pk_fma_f32 v[136:137], v[136:137], v[48:49], v[56:57]
    v_pk_fma_f32 v[138:139], v[138:139], v[50:51], v[58:59]
    v_pk_fma_f32 v[140:141], v[140:141], v[52:53], v[60:61]
    v_pk_fma_f32 v[142:143], v[142:143], v[54:55], v[62:63]
    v_cvt_pk_bf16_f32 v228, v136, v137
    v_cvt_pk_bf16_f32 v229, v138, v139
    v_cvt_pk_bf16_f32 v230, v140, v141
    v_cvt_pk_bf16_f32 v231, v142, v143
    v_pk_fma_f32 v[144:145], v[144:145], v[236:237], v[236:237] op_sel:[0,0,1] op_sel_hi:[1,0,1]
    v_pk_fma_f32 v[146:147], v[146:147], v[236:237], v[236:237] op_sel:[0,0,1] op_sel_hi:[1,0,1]
    v_pk_fma_f32 v[148:149], v[148:149], v[236:237], v[236:237] op_sel:[0,0,1] op_sel_hi:[1,0,1]
    v_pk_fma_f32 v[150:151], v[150:151], v[236:237], v[236:237] op_sel:[0,0,1] op_sel_hi:[1,0,1]
    ds_write_b128 v241, v[228:231] offset:49152
    s_waitcnt lgkmcnt(12)
    v_pk_fma_f32 v[144:145], v[144:145], v[64:65], v[72:73]
    v_pk_fma_f32 v[146:147], v[146:147], v[66:67], v[74:75]
    v_pk_fma_f32 v[148:149], v[148:149], v[68:69], v[76:77]
    v_pk_fma_f32 v[150:151], v[150:151], v[70:71], v[78:79]
    v_cvt_pk_bf16_f32 v224, v144, v145
    v_cvt_pk_bf16_f32 v225, v146, v147
    v_cvt_pk_bf16_f32 v226, v148, v149
    v_cvt_pk_bf16_f32 v227, v150, v151
    v_pk_fma_f32 v[152:153], v[152:153], v[236:237], v[236:237] op_sel:[0,0,1] op_sel_hi:[1,0,1]
    v_pk_fma_f32 v[154:155], v[154:155], v[236:237], v[236:237] op_sel:[0,0,1] op_sel_hi:[1,0,1]
    v_pk_fma_f32 v[156:157], v[156:157], v[236:237], v[236:237] op_sel:[0,0,1] op_sel_hi:[1,0,1]
    v_pk_fma_f32 v[158:159], v[158:159], v[236:237], v[236:237] op_sel:[0,0,1] op_sel_hi:[1,0,1]
    ds_write_b128 v242, v[224:227] offset:0
    s_waitcnt lgkmcnt(9)
    v_pk_fma_f32 v[152:153], v[152:153], v[80:81], v[88:89]
    v_pk_fma_f32 v[154:155], v[154:155], v[82:83], v[90:91]
    v_pk_fma_f32 v[156:157], v[156:157], v[84:85], v[92:93]
    v_pk_fma_f32 v[158:159], v[158:159], v[86:87], v[94:95]
    v_cvt_pk_bf16_f32 v228, v152, v153
    v_cvt_pk_bf16_f32 v229, v154, v155
    v_cvt_pk_bf16_f32 v230, v156, v157
    v_cvt_pk_bf16_f32 v231, v158, v159
    v_pk_fma_f32 v[160:161], v[160:161], v[236:237], v[236:237] op_sel:[0,0,1] op_sel_hi:[1,0,1]
    v_pk_fma_f32 v[162:163], v[162:163], v[236:237], v[236:237] op_sel:[0,0,1] op_sel_hi:[1,0,1]
    v_pk_fma_f32 v[164:165], v[164:165], v[236:237], v[236:237] op_sel:[0,0,1] op_sel_hi:[1,0,1]
    v_pk_fma_f32 v[166:167], v[166:167], v[236:237], v[236:237] op_sel:[0,0,1] op_sel_hi:[1,0,1]
    ds_write_b128 v242, v[228:231] offset:16384
    s_waitcnt lgkmcnt(6)
    v_pk_fma_f32 v[160:161], v[160:161], v[96:97], v[104:105]
    v_pk_fma_f32 v[162:163], v[162:163], v[98:99], v[106:107]
    v_pk_fma_f32 v[164:165], v[164:165], v[100:101], v[108:109]
    v_pk_fma_f32 v[166:167], v[166:167], v[102:103], v[110:111]
    v_cvt_pk_bf16_f32 v224, v160, v161
    v_cvt_pk_bf16_f32 v225, v162, v163
    v_cvt_pk_bf16_f32 v226, v164, v165
    v_cvt_pk_bf16_f32 v227, v166, v167
    ds_write_b128 v242, v[224:227] offset:32768
    s_waitcnt vmcnt(6)
    v_lshlrev_b32 v236, 16, v196
    s_nop 1
    v_mov_b32_dpp v238, v236 quad_perm:[0,0,0,0] row_mask:0xf bank_mask:0xf
    s_nop 1
    v_mov_b32_dpp v238, v238 row_shr:4 row_mask:0xf bank_mask:0xa
    v_dot2_f32_bf16 v112, v196, s45, v238 neg_lo:[0,0,1]
    v_dot2_f32_bf16 v113, v196, s46, v238 neg_lo:[0,0,1]
    v_dot2_f32_bf16 v114, v197, s45, v238 neg_lo:[0,0,1]
    v_dot2_f32_bf16 v115, v197, s46, v238 neg_lo:[0,0,1]
    v_dot2_f32_bf16 v116, v198, s45, v238 neg_lo:[0,0,1]
    v_dot2_f32_bf16 v117, v198, s46, v238 neg_lo:[0,0,1]
    v_dot2_f32_bf16 v118, v199, s45, v238 neg_lo:[0,0,1]
    v_dot2_f32_bf16 v119, v199, s46, v238 neg_lo:[0,0,1]
    v_pk_add_f32 v[232:233], v[112:113], v[114:115]
    v_pk_mul_f32 v[234:235], v[112:113], v[112:113]
    v_pk_fma_f32 v[234:235], v[114:115], v[114:115], v[234:235]
    v_pk_add_f32 v[232:233], v[232:233], v[116:117]
    v_pk_fma_f32 v[234:235], v[116:117], v[116:117], v[234:235]
    v_pk_add_f32 v[232:233], v[232:233], v[118:119]
    v_pk_fma_f32 v[234:235], v[118:119], v[118:119], v[234:235]
    s_waitcnt vmcnt(5)
    v_dot2_f32_bf16 v120, v200, s45, v238 neg_lo:[0,0,1]
    v_dot2_f32_bf16 v121, v200, s46, v238 neg_lo:[0,0,1]
    v_dot2_f32_bf16 v122, v201, s45, v238 neg_lo:[0,0,1]
    v_dot2_f32_bf16 v123, v201, s46, v238 neg_lo:[0,0,1]
    v_dot2_f32_bf16 v124, v202, s45, v238 neg_lo:[0,0,1]
    v_dot2_f32_bf16 v125, v202, s46, v238 neg_lo:[0,0,1]
    v_dot2_f32_bf16 v126, v203, s45, v238 neg_lo:[0,0,1]
    v_dot2_f32_bf16 v127, v203, s46, v238 neg_lo:[0,0,1]
    v_pk_add_f32 v[232:233], v[232:233], v[120:121]
    v_pk_fma_f32 v[234:235], v[120:121], v[120:121], v[234:235]
    v_pk_add_f32 v[232:233], v[232:233], v[122:123]
    v_pk_fma_f32 v[234:235], v[122:123], v[122:123], v[234:235]
    v_pk_add_f32 v[232:233], v[232:233], v[124:125]
    v_pk_fma_f32 v[234:235], v[124:125], v[124:125], v[234:235]
    v_pk_add_f32 v[232:233], v[232:233], v[126:127]
    v_pk_fma_f32 v[234:235], v[126:127], v[126:127], v[234:235]
    s_waitcnt vmcnt(4)
    v_dot2_f32_bf16 v128, v204, s45, v238 neg_lo:[0,0,1]
    v_dot2_f32_bf16 v129, v204, s46, v238 neg_lo:[0,0,1]
    v_dot2_f32_bf16 v130, v205, s45, v238 neg_lo:[0,0,1]
    v_dot2_f32_bf16 v131, v205, s46, v238 neg_lo:[0,0,1]
    v_dot2_f32_bf16 v132, v206, s45, v238 neg_lo:[0,0,1]
    v_dot2_f32_bf16 v133, v206, s46, v238 neg_lo:[0,0,1]
    v_dot2_f32_bf16 v134, v207, s45, v238 neg_lo:[0,0,1]
    v_dot2_f32_bf16 v135, v207, s46, v238 neg_lo:[0,0,1]
    v_pk_add_f32 v[232:233], v[232:233], v[128:129]
    v_pk_fma_f32 v[234:235], v[128:129], v[128:129], v[234:235]
    v_pk_add_f32 v[232:233], v[232:233], v[130:131]
    v_pk_fma_f32 v[234:235], v[130:131], v[130:131], v[234:235]
    v_pk_add_f32 v[232:233], v[232:233], v[132:133]
    v_pk_fma_f32 v[234:235], v[132:133], v[132:133], v[234:235]
    v_pk_add_f32 v[232:233], v[232:233], v[134:135]
    v_pk_fma_f32 v[234:235], v[134:135], v[134:135], v[234:235]
    s_waitcnt vmcnt(3)
    s_add_u32 m0, s52, 0
    s_add_u32 s48, s50, 0
    buffer_load_dwordx4 v243, s[20:23], s48 offen  lds
    v_dot2_f32_bf16 v136, v208, s45, v238 neg_lo:[0,0,1]
    v_dot2_f32_bf16 v137, v208, s46, v238 neg_lo:[0,0,1]
    v_dot2_f32_bf16 v138, v209, s45, v238 neg_lo:[0,0,1]
    v_dot2_f32_bf16 v139, v209, s46, v238 neg_lo:[0,0,1]
    v_dot2_f32_bf16 v140, v210, s45, v238 neg_lo:[0,0,1]
    v_dot2_f32_bf16 v141, v210, s46, v238 neg_lo:[0,0,1]
    v_dot2_f32_bf16 v142, v211, s45, v238 neg_lo:[0,0,1]
    v_dot2_f32_bf16 v143, v211, s46, v238 neg_lo:[0,0,1]
    v_pk_add_f32 v[232:233], v[232:233], v[136:137]
    v_pk_fma_f32 v[234:235], v[136:137], v[136:137], v[234:235]
    v_pk_add_f32 v[232:233], v[232:233], v[138:139]
    v_pk_fma_f32 v[234:235], v[138:139], v[138:139], v[234:235]
    v_pk_add_f32 v[232:233], v[232:233], v[140:141]
    v_pk_fma_f32 v[234:235], v[140:141], v[140:141], v[234:235]
    v_pk_add_f32 v[232:233], v[232:233], v[142:143]
    v_pk_fma_f32 v[234:235], v[142:143], v[142:143], v[234:235]
    s_waitcnt vmcnt(3)
    s_add_u32 m0, s52, 8192
    s_add_u32 s48, s50, 57344
    buffer_load_dwordx4 v243, s[20:23], s48 offen  lds
    v_dot2_f32_bf16 v144, v212, s45, v238 neg_lo:[0,0,1]
    v_dot2_f32_bf16 v145, v212, s46, v238 neg_lo:[0,0,1]
    v_dot2_f32_bf16 v146, v213, s45, v238 neg_lo:[0,0,1]
    v_dot2_f32_bf16 v147, v213, s46, v238 neg_lo:[0,0,1]
    v_dot2_f32_bf16 v148, v214, s45, v238 neg_lo:[0,0,1]
    v_dot2_f32_bf16 v149, v214, s46, v238 neg_lo:[0,0,1]
    v_dot2_f32_bf16 v150, v215, s45, v238 neg_lo:[0,0,1]
    v_dot2_f32_bf16 v151, v215, s46, v238 neg_lo:[0,0,1]
    v_pk_add_f32 v[232:233], v[232:233], v[144:145]
    v_pk_fma_f32 v[234:235], v[144:145], v[144:145], v[234:235]
    v_pk_add_f32 v[232:233], v[232:233], v[146:147]
    v_pk_fma_f32 v[234:235], v[146:147], v[146:147], v[234:235]
    v_pk_add_f32 v[232:233], v[232:233], v[148:149]
    v_pk_fma_f32 v[234:235], v[148:149], v[148:149], v[234:235]
    v_pk_add_f32 v[232:233], v[232:233], v[150:151]
    v_pk_fma_f32 v[234:235], v[150:151], v[150:151], v[234:235]
    s_waitcnt vmcnt(3)
    s_add_u32 m0, s52, 16384
    s_add_u32 s48, s50, 114688
    buffer_load_dwordx4 v243, s[20:23], s48 offen  lds
    v_dot2_f32_bf16 v152, v216, s45, v238 neg_lo:[0,0,1]
    v_dot2_f32_bf16 v153, v216, s46, v238 neg_lo:[0,0,1]
    v_dot2_f32_bf16 v154, v217, s45, v238 neg_lo:[0,0,1]
    v_dot2_f32_bf16 v155, v217, s46, v238 neg_lo:[0,0,1]
    v_dot2_f32_bf16 v156, v218, s45, v238 neg_lo:[0,0,1]
    v_dot2_f32_bf16 v157, v218, s46, v238 neg_lo:[0,0,1]
    v_dot2_f32_bf16 v158, v219, s45, v238 neg_lo:[0,0,1]
    v_dot2_f32_bf16 v159, v219, s46, v238 neg_lo:[0,0,1]
    v_pk_add_f32 v[232:233], v[232:233], v[152:153]
    v_pk_fma_f32 v[234:235], v[152:153], v[152:153], v[234:235]
    v_pk_add_f32 v[232:233], v[232:233], v[154:155]
    v_pk_fma_f32 v[234:235], v[154:155], v[154:155], v[234:235]
    v_pk_add_f32 v[232:233], v[232:233], v[156:157]
    v_pk_fma_f32 v[234:235], v[156:157], v[156:157], v[234:235]
    v_pk_add_f32 v[232:233], v[232:233], v[158:159]
    v_pk_fma_f32 v[234:235], v[158:159], v[158:159], v[234:235]
    s_waitcnt vmcnt(3)
    s_add_u32 m0, s52, 24576
    s_add_u32 s48, s50, 172032
    buffer_load_dwordx4 v243, s[20:23], s48 offen  lds
    v_dot2_f32_bf16 v160, v220, s45, v238 neg_lo:[0,0,1]
    v_dot2_f32_bf16 v161, v220, s46, v238 neg_lo:[0,0,1]
    v_dot2_f32_bf16 v162, v221, s45, v238 neg_lo:[0,0,1]
    v_dot2_f32_bf16 v163, v221, s46, v238 neg_lo:[0,0,1]
    v_dot2_f32_bf16 v164, v222, s45, v238 neg_lo:[0,0,1]
    v_dot2_f32_bf16 v165, v222, s46, v238 neg_lo:[0,0,1]
    v_dot2_f32_bf16 v166, v223, s45, v238 neg_lo:[0,0,1]
    v_dot2_f32_bf16 v167, v223, s46, v238 neg_lo:[0,0,1]
    v_pk_add_f32 v[232:233], v[232:233], v[160:161]
    v_pk_fma_f32 v[234:235], v[160:161], v[160:161], v[234:235]
    v_pk_add_f32 v[232:233], v[232:233], v[162:163]
    v_pk_fma_f32 v[234:235], v[162:163], v[162:163], v[234:235]
    v_pk_add_f32 v[232:233], v[232:233], v[164:165]
    v_pk_fma_f32 v[234:235], v[164:165], v[164:165], v[234:235]
    v_pk_add_f32 v[232:233], v[232:233], v[166:167]
    v_pk_fma_f32 v[234:235], v[166:167], v[166:167], v[234:235]
    v_add_f32 v232, v232, v233
    v_add_f32 v234, v234, v235
    v_subrev_u32 v255, s41, v240
    v_add_f32_dpp v232, v232, v232 quad_perm:[1,0,3,2] row_mask:0xf bank_mask:0xf
    v_add_f32_dpp v234, v234, v234 quad_perm:[1,0,3,2] row_mask:0xf bank_mask:0xf
    s_nop 0
    v_add_f32_dpp v232, v232, v232 quad_perm:[2,3,0,1] row_mask:0xf bank_mask:0xf
    v_add_f32_dpp v234, v234, v234 quad_perm:[2,3,0,1] row_mask:0xf bank_mask:0xf
    s_nop 0
    v_add_f32_dpp v232, v232, v232 row_half_mirror row_mask:0xf bank_mask:0xf
    v_add_f32_dpp v234, v234, v234 row_half_mirror row_mask:0xf bank_mask:0xf
    v_mul_f32 v232, 0x3b124925, v232
    v_mul_f32 v234, 0x3b124925, v234
    v_fma_f32 v234, -v232, v232, v234
    v_add_f32 v232, v232, v238
    v_cvt_pk_bf16_f32 v234, 0, v234
    v_cvt_pk_bf16_f32 v232, 0, v232
    v_add_f32 v234, 0x3727c5ac, v234
    v_cvt_pk_bf16_f32 v234, 0, v234
    v_sqrt_f32 v234, v234
    v_sub_f32 v232, v238, v232
    v_cvt_pk_bf16_f32 v234, 0, v234
    v_rcp_f32 v236, v234
    s_nop 0
    v_mul_f32 v237, v232, v236
    v_pk_fma_f32 v[112:113], v[112:113], v[236:237], v[236:237] op_sel:[0,0,1] op_sel_hi:[1,0,1]
    v_pk_fma_f32 v[114:115], v[114:115], v[236:237], v[236:237] op_sel:[0,0,1] op_sel_hi:[1,0,1]
    v_pk_fma_f32 v[116:117], v[116:117], v[236:237], v[236:237] op_sel:[0,0,1] op_sel_hi:[1,0,1]
    v_pk_fma_f32 v[118:119], v[118:119], v[236:237], v[236:237] op_sel:[0,0,1] op_sel_hi:[1,0,1]
    v_pk_fma_f32 v[112:113], v[112:113], v[0:1], v[8:9]
    v_pk_fma_f32 v[114:115], v[114:115], v[2:3], v[10:11]
    v_pk_fma_f32 v[116:117], v[116:117], v[4:5], v[12:13]
    v_pk_fma_f32 v[118:119], v[118:119], v[6:7], v[14:15]
    v_cvt_pk_bf16_f32 v224, v112, v113
    v_cvt_pk_bf16_f32 v225, v114, v115
    v_cvt_pk_bf16_f32 v226, v116, v117
    v_cvt_pk_bf16_f32 v227, v118, v119
    v_pk_fma_f32 v[120:121], v[120:121], v[236:237], v[236:237] op_sel:[0,0,1] op_sel_hi:[1,0,1]
    v_pk_fma_f32 v[122:123], v[122:123], v[236:237], v[236:237] op_sel:[0,0,1] op_sel_hi:[1,0,1]
    v_pk_fma_f32 v[124:125], v[124:125], v[236:237], v[236:237] op_sel:[0,0,1] op_sel_hi:[1,0,1]
    v_pk_fma_f32 v[126:127], v[126:127], v[236:237], v[236:237] op_sel:[0,0,1] op_sel_hi:[1,0,1]
    ds_write_b128 v241, v[224:227] offset:8192
    v_pk_fma_f32 v[120:121], v[120:121], v[16:17], v[24:25]
    v_pk_fma_f32 v[122:123], v[122:123], v[18:19], v[26:27]
    v_pk_fma_f32 v[124:125], v[124:125], v[20:21], v[28:29]
    v_pk_fma_f32 v[126:127], v[126:127], v[22:23], v[30:31]
    v_cvt_pk_bf16_f32 v228, v120, v121
    v_cvt_pk_bf16_f32 v229, v122, v123
    v_cvt_pk_bf16_f32 v230, v124, v125
    v_cvt_pk_bf16_f32 v231, v126, v127
    v_pk_fma_f32 v[128:129], v[128:129], v[236:237], v[236:237] op_sel:[0,0,1] op_sel_hi:[1,0,1]
    v_pk_fma_f32 v[130:131], v[130:131], v[236:237], v[236:237] op_sel:[0,0,1] op_sel_hi:[1,0,1]
    v_pk_fma_f32 v[132:133], v[132:133], v[236:237], v[236:237] op_sel:[0,0,1] op_sel_hi:[1,0,1]
    v_pk_fma_f32 v[134:135], v[134:135], v[236:237], v[236:237] op_sel:[0,0,1] op_sel_hi:[1,0,1]
    ds_write_b128 v241, v[228:231] offset:24576
    v_pk_fma_f32 v[128:129], v[128:129], v[32:33], v[40:41]
    v_pk_fma_f32 v[130:131], v[130:131], v[34:35], v[42:43]
    v_pk_fma_f32 v[132:133], v[132:133], v[36:37], v[44:45]
    v_pk_fma_f32 v[134:135], v[134:135], v[38:39], v[46:47]
    v_cvt_pk_bf16_f32 v224, v128, v129
    v_cvt_pk_bf16_f32 v225, v130, v131
    v_cvt_pk_bf16_f32 v226, v132, v133
    v_cvt_pk_bf16_f32 v227, v134, v135
    v_pk_fma_f32 v[136:137], v[136:137], v[236:237], v[236:237] op_sel:[0,0,1] op_sel_hi:[1,0,1]
    v_pk_fma_f32 v[138:139], v[138:139], v[236:237], v[236:237] op_sel:[0,0,1] op_sel_hi:[1,0,1]
    v_pk_fma_f32 v[140:141], v[140:141], v[236:237], v[236:237] op_sel:[0,0,1] op_sel_hi:[1,0,1]
    v_pk_fma_f32 v[142:143], v[142:143], v[236:237], v[236:237] op_sel:[0,0,1] op_sel_hi:[1,0,1]
    ds_write_b128 v241, v[224:227] offset:40960
    v_pk_fma_f32 v[136:137], v[136:137], v[48:49], v[56:57]
    v_pk_fma_f32 v[138:139], v[138:139], v[50:51], v[58:59]
    v_pk_fma_f32 v[140:141], v[140:141], v[52:53], v[60:61]
    v_pk_fma_f32 v[142:143], v[142:143], v[54:55], v[62:63]
    v_cvt_pk_bf16_f32 v228, v136, v137
    v_cvt_pk_bf16_f32 v229, v138, v139
    v_cvt_pk_bf16_f32 v230, v140, v141
    v_cvt_pk_bf16_f32 v231, v142, v143
    v_pk_fma_f32 v[144:145], v[144:145], v[236:237], v[236:237] op_sel:[0,0,1] op_sel_hi:[1,0,1]
    v_pk_fma_f32 v[146:147], v[146:147], v[236:237], v[236:237] op_sel:[0,0,1] op_sel_hi:[1,0,1]
    v_pk_fma_f32 v[148:149], v[148:149], v[236:237], v[236:237] op_sel:[0,0,1] op_sel_hi:[1,0,1]
    v_pk_fma_f32 v[150:151], v[150:151], v[236:237], v[236:237] op_sel:[0,0,1] op_sel_hi:[1,0,1]
    ds_write_b128 v241, v[228:231] offset:57344
    v_pk_fma_f32 v[144:145], v[144:145], v[64:65], v[72:73]
    v_pk_fma_f32 v[146:147], v[146:147], v[66:67], v[74:75]
    v_pk_fma_f32 v[148:149], v[148:149], v[68:69], v[76:77]
    v_pk_fma_f32 v[150:151], v[150:151], v[70:71], v[78:79]
    v_cvt_pk_bf16_f32 v224, v144, v145
    v_cvt_pk_bf16_f32 v225, v146, v147
    v_cvt_pk_bf16_f32 v226, v148, v149
    v_cvt_pk_bf16_f32 v227, v150, v151
    v_pk_fma_f32 v[152:153], v[152:153], v[236:237], v[236:237] op_sel:[0,0,1] op_sel_hi:[1,0,1]
    v_pk_fma_f32 v[154:155], v[154:155], v[236:237], v[236:237] op_sel:[0,0,1] op_sel_hi:[1,0,1]
    v_pk_fma_f32 v[156:157], v[156:157], v[236:237], v[236:237] op_sel:[0,0,1] op_sel_hi:[1,0,1]
    v_pk_fma_f32 v[158:159], v[158:159], v[236:237], v[236:237] op_sel:[0,0,1] op_sel_hi:[1,0,1]
    ds_write_b128 v242, v[224:227] offset:8192
    v_pk_fma_f32 v[152:153], v[152:153], v[80:81], v[88:89]
    v_pk_fma_f32 v[154:155], v[154:155], v[82:83], v[90:91]
    v_pk_fma_f32 v[156:157], v[156:157], v[84:85], v[92:93]
    v_pk_fma_f32 v[158:159], v[158:159], v[86:87], v[94:95]
    v_cvt_pk_bf16_f32 v228, v152, v153
    v_cvt_pk_bf16_f32 v229, v154, v155
    v_cvt_pk_bf16_f32 v230, v156, v157
    v_cvt_pk_bf16_f32 v231, v158, v159
    v_pk_fma_f32 v[160:161], v[160:161], v[236:237], v[236:237] op_sel:[0,0,1] op_sel_hi:[1,0,1]
    v_pk_fma_f32 v[162:163], v[162:163], v[236:237], v[236:237] op_sel:[0,0,1] op_sel_hi:[1,0,1]
    v_pk_fma_f32 v[164:165], v[164:165], v[236:237], v[236:237] op_sel:[0,0,1] op_sel_hi:[1,0,1]
    v_pk_fma_f32 v[166:167], v[166:167], v[236:237], v[236:237] op_sel:[0,0,1] op_sel_hi:[1,0,1]
    ds_write_b128 v242, v[228:231] offset:24576
    v_pk_fma_f32 v[160:161], v[160:161], v[96:97], v[104:105]
    v_pk_fma_f32 v[162:163], v[162:163], v[98:99], v[106:107]
    v_pk_fma_f32 v[164:165], v[164:165], v[100:101], v[108:109]
    v_pk_fma_f32 v[166:167], v[166:167], v[102:103], v[110:111]
    v_cvt_pk_bf16_f32 v224, v160, v161
    v_cvt_pk_bf16_f32 v225, v162, v163
    v_cvt_pk_bf16_f32 v226, v164, v165
    v_cvt_pk_bf16_f32 v227, v166, v167
    ds_write_b128 v242, v[224:227] offset:40960
    s_waitcnt vmcnt(3)
    s_waitcnt vmcnt(2)
    s_waitcnt lgkmcnt(0)
    s_barrier
    ds_read_b64_tr_b16 v[224:225], v253 offset:0
    ds_read_b64_tr_b16 v[226:227], v253 offset:512
    ds_read_b128 v[0:3], v248 offset:0
    ds_read_b128 v[4:7], v248 offset:2048
    ds_read_b128 v[8:11], v248 offset:4096
    ds_read_b128 v[12:15], v248 offset:6144
    ds_read_b64_tr_b16 v[228:229], v244 offset:0
    ds_read_b64_tr_b16 v[230:231], v244 offset:512
    ds_read_b128 v[16:19], v249 offset:0
    ds_read_b128 v[20:23], v249 offset:2048
    ds_read_b128 v[24:27], v249 offset:4096
    ds_read_b128 v[28:31], v249 offset:6144
    s_waitcnt lgkmcnt(6)
    v_mfma_f32_16x16x32_bf16 v[112:115], v[224:227], v[0:3], 0
    ds_read_b64_tr_b16 v[232:233], v253 offset:4096
    v_mfma_f32_16x16x32_bf16 v[116:119], v[224:227], v[4:7], 0
    ds_read_b64_tr_b16 v[234:235], v253 offset:4608
    ds_read_b128 v[32:35], v248 offset:16384
    v_mfma_f32_16x16x32_bf16 v[120:123], v[224:227], v[8:11], 0
    ds_read_b128 v[36:39], v248 offset:18432
    v_mfma_f32_16x16x32_bf16 v[124:127], v[224:227], v[12:15], 0
    ds_read_b128 v[40:43], v248 offset:20480
    s_waitcnt lgkmcnt(9)
    v_mfma_f32_16x16x32_bf16 v[128:131], v[228:231], v[0:3], 0
    ds_read_b64_tr_b16 v[236:237], v244 offset:4096
    v_mfma_f32_16x16x32_bf16 v[132:135], v[228:231], v[4:7], 0
    ds_read_b64_tr_b16 v[238:239], v244 offset:4608
    ds_read_b128 v[44:47], v248 offset:22528
    v_mfma_f32_16x16x32_bf16 v[136:139], v[228:231], v[8:11], 0
    ds_read_b128 v[48:51], v249 offset:16384
    v_mfma_f32_16x16x32_bf16 v[140:143], v[228:231], v[12:15], 0
    ds_read_b128 v[52:55], v249 offset:18432
    s_waitcnt lgkmcnt(10)
    s_waitcnt lgkmcnt(8)
    v_mfma_f32_16x16x32_bf16 v[112:115], v[232:235], v[16:19], v[112:115]
    ds_read_b64_tr_b16 v[240:241], v253 offset:8192
    v_mfma_f32_16x16x32_bf16 v[116:119], v[232:235], v[20:23], v[116:119]
    ds_read_b64_tr_b16 v[242:243], v253 offset:8704
    ds_read_b128 v[56:59], v249 offset:20480
    v_mfma_f32_16x16x32_bf16 v[120:123], v[232:235], v[24:27], v[120:123]
    ds_read_b128 v[60:63], v249 offset:22528
    v_mfma_f32_16x16x32_bf16 v[124:127], v[232:235], v[28:31], v[124:127]
    ds_read_b128 v[64:67], v248 offset:32768
    s_waitcnt lgkmcnt(8)
    v_mfma_f32_16x16x32_bf16 v[128:131], v[236:239], v[16:19], v[128:131]
    ds_read_b64_tr_b16 v[224:225], v244 offset:8192
    v_mfma_f32_16x16x32_bf16 v[132:135], v[236:239], v[20:23], v[132:135]
    ds_read_b64_tr_b16 v[226:227], v244 offset:8704
    ds_read_b128 v[68:71], v248 offset:34816
    v_mfma_f32_16x16x32_bf16 v[136:139], v[236:239], v[24:27], v[136:139]
    ds_read_b128 v[72:75], v248 offset:36864
    v_mfma_f32_16x16x32_bf16 v[140:143], v[236:239], v[28:31], v[140:143]
    ds_read_b128 v[76:79], v248 offset:38912
    s_waitcnt lgkmcnt(12)
    s_waitcnt lgkmcnt(8)
    v_mfma_f32_16x16x32_bf16 v[112:115], v[240:243], v[32:35], v[112:115]
    ds_read_b64_tr_b16 v[228:229], v253 offset:12288
    v_mfma_f32_16x16x32_bf16 v[116:119], v[240:243], v[36:39], v[116:119]
    ds_read_b64_tr_b16 v[230:231], v253 offset:12800
    ds_read_b128 v[80:83], v249 offset:32768
    v_mfma_f32_16x16x32_bf16 v[120:123], v[240:243], v[40:43], v[120:123]
    ds_read_b128 v[84:87], v249 offset:34816
    v_mfma_f32_16x16x32_bf16 v[124:127], v[240:243], v[44:47], v[124:127]
    ds_read_b128 v[88:91], v249 offset:36864
    s_waitcnt lgkmcnt(8)
    v_mfma_f32_16x16x32_bf16 v[128:131], v[224:227], v[32:35], v[128:131]
    ds_read_b64_tr_b16 v[232:233], v244 offset:12288
    v_mfma_f32_16x16x32_bf16 v[132:135], v[224:227], v[36:39], v[132:135]
    ds_read_b64_tr_b16 v[234:235], v244 offset:12800
    ds_read_b128 v[92:95], v249 offset:38912
    v_mfma_f32_16x16x32_bf16 v[136:139], v[224:227], v[40:43], v[136:139]
    ds_read_b128 v[96:99], v248 offset:49152
    v_mfma_f32_16x16x32_bf16 v[140:143], v[224:227], v[44:47], v[140:143]
    ds_read_b128 v[100:103], v248 offset:51200
    s_waitcnt lgkmcnt(8)
    v_mfma_f32_16x16x32_bf16 v[112:115], v[228:231], v[48:51], v[112:115]
    s_waitcnt vmcnt(0)
    s_barrier
    ds_read_b64_tr_b16 v[236:237], v253 offset:16384
    v_mfma_f32_16x16x32_bf16 v[116:119], v[228:231], v[52:55], v[116:119]
    ds_read_b64_tr_b16 v[238:239], v253 offset:16896
    ds_read_b128 v[104:107], v248 offset:53248
    v_mfma_f32_16x16x32_bf16 v[120:123], v[228:231], v[56:59], v[120:123]
    ds_read_b128 v[108:111], v248 offset:55296
    v_mfma_f32_16x16x32_bf16 v[124:127], v[228:231], v[60:63], v[124:127]
    s_waitcnt lgkmcnt(7)
    v_mfma_f32_16x16x32_bf16 v[128:131], v[232:235], v[48:51], v[128:131]
    ds_read_b64_tr_b16 v[240:241], v244 offset:16384
    v_mfma_f32_16x16x32_bf16 v[132:135], v[232:235], v[52:55], v[132:135]
    ds_read_b64_tr_b16 v[242:243], v244 offset:16896
    v_mfma_f32_16x16x32_bf16 v[136:139], v[232:235], v[56:59], v[136:139]
    v_mfma_f32_16x16x32_bf16 v[140:143], v[232:235], v[60:63], v[140:143]
    s_waitcnt lgkmcnt(4)
    v_mfma_f32_16x16x32_bf16 v[112:115], v[236:239], v[64:67], v[112:115]
    ds_read_b64_tr_b16 v[224:225], v253 offset:20480
    v_mfma_f32_16x16x32_bf16 v[116:119], v[236:239], v[68:71], v[116:119]
    ds_read_b64_tr_b16 v[226:227], v253 offset:20992
    v_mfma_f32_16x16x32_bf16 v[120:123], v[236:239], v[72:75], v[120:123]
    v_mfma_f32_16x16x32_bf16 v[124:127], v[236:239], v[76:79], v[124:127]
    s_waitcnt lgkmcnt(2)
    v_mfma_f32_16x16x32_bf16 v[128:131], v[240:243], v[64:67], v[128:131]
    ds_read_b64_tr_b16 v[228:229], v244 offset:20480
    v_mfma_f32_16x16x32_bf16 v[132:135], v[240:243], v[68:71], v[132:135]
    ds_read_b64_tr_b16 v[230:231], v244 offset:20992
    v_mfma_f32_16x16x32_bf16 v[136:139], v[240:243], v[72:75], v[136:139]
    v_mfma_f32_16x16x32_bf16 v[140:143], v[240:243], v[76:79], v[140:143]
    s_waitcnt lgkmcnt(2)
    v_mfma_f32_16x16x32_bf16 v[112:115], v[224:227], v[80:83], v[112:115]
    ds_read_b64_tr_b16 v[232:233], v253 offset:24576
    v_mfma_f32_16x16x32_bf16 v[116:119], v[224:227], v[84:87], v[116:119]
    ds_read_b64_tr_b16 v[234:235], v253 offset:25088
    v_mfma_f32_16x16x32_bf16 v[120:123], v[224:227], v[88:91], v[120:123]
    v_mfma_f32_16x16x32_bf16 v[124:127], v[224:227], v[92:95], v[124:127]
    s_waitcnt lgkmcnt(2)
    v_mfma_f32_16x16x32_bf16 v[128:131], v[228:231], v[80:83], v[128:131]
    ds_read_b64_tr_b16 v[236:237], v244 offset:24576
    v_mfma_f32_16x16x32_bf16 v[132:135], v[228:231], v[84:87], v[132:135]
    ds_read_b64_tr_b16 v[238:239], v244 offset:25088
    v_mfma_f32_16x16x32_bf16 v[136:139], v[228:231], v[88:91], v[136:139]
    v_mfma_f32_16x16x32_bf16 v[140:143], v[228:231], v[92:95], v[140:143]
    s_waitcnt lgkmcnt(2)
    v_mfma_f32_16x16x32_bf16 v[112:115], v[232:235], v[96:99], v[112:115]
    s_waitcnt lgkmcnt(0)
    s_barrier
    ds_read_b64_tr_b16 v[240:241], v247 offset:28672
    v_mfma_f32_16x16x32_bf16 v[116:119], v[232:235], v[100:103], v[116:119]
    ds_read_b64_tr_b16 v[242:243], v247 offset:28928
    v_mfma_f32_16x16x32_bf16 v[120:123], v[232:235], v[104:107], v[120:123]
    v_mfma_f32_16x16x32_bf16 v[124:127], v[232:235], v[108:111], v[124:127]
    v_mfma_f32_16x16x32_bf16 v[128:131], v[236:239], v[96:99], v[128:131]
    ds_read_b64_tr_b16 v[224:225], v247 offset:30720
    v_mfma_f32_16x16x32_bf16 v[132:135], v[236:239], v[100:103], v[132:135]
    ds_read_b64_tr_b16 v[226:227], v247 offset:30976
    v_mfma_f32_16x16x32_bf16 v[136:139], v[236:239], v[104:107], v[136:139]
    v_mfma_f32_16x16x32_bf16 v[140:143], v[236:239], v[108:111], v[140:143]
    s_waitcnt lgkmcnt(2)
    v_mfma_f32_16x16x32_bf16 v[208:211], v[240:243], v[0:3], 0
    ds_read_b64_tr_b16 v[228:229], v247 offset:32768
    v_mfma_f32_16x16x32_bf16 v[212:215], v[240:243], v[4:7], 0
    ds_read_b64_tr_b16 v[230:231], v247 offset:33024
    v_mfma_f32_16x16x32_bf16 v[216:219], v[240:243], v[8:11], 0
    v_mfma_f32_16x16x32_bf16 v[220:223], v[240:243], v[12:15], 0
    s_waitcnt lgkmcnt(2)
    v_mfma_f32_16x16x32_bf16 v[208:211], v[224:227], v[16:19], v[208:211]
    ds_read_b64_tr_b16 v[232:233], v247 offset:34816
    v_mfma_f32_16x16x32_bf16 v[212:215], v[224:227], v[20:23], v[212:215]
    ds_read_b64_tr_b16 v[234:235], v247 offset:35072
    v_mfma_f32_16x16x32_bf16 v[216:219], v[224:227], v[24:27], v[216:219]
    v_mfma_f32_16x16x32_bf16 v[220:223], v[224:227], v[28:31], v[220:223]
    s_waitcnt lgkmcnt(2)
    v_mfma_f32_16x16x32_bf16 v[208:211], v[228:231], v[32:35], v[208:211]
    ds_read_b64_tr_b16 v[236:237], v247 offset:36864
    v_mfma_f32_16x16x32_bf16 v[212:215], v[228:231], v[36:39], v[212:215]
    ds_read_b64_tr_b16 v[238:239], v247 offset:37120
    v_mfma_f32_16x16x32_bf16 v[216:219], v[228:231], v[40:43], v[216:219]
    v_mfma_f32_16x16x32_bf16 v[220:223], v[228:231], v[44:47], v[220:223]
    s_waitcnt lgkmcnt(2)
    v_mfma_f32_16x16x32_bf16 v[208:211], v[232:235], v[48:51], v[208:211]
    ds_read_b64_tr_b16 v[240:241], v247 offset:38912
    v_mfma_f32_16x16x32_bf16 v[212:215], v[232:235], v[52:55], v[212:215]
    ds_read_b64_tr_b16 v[242:243], v247 offset:39168
    v_mfma_f32_16x16x32_bf16 v[216:219], v[232:235], v[56:59], v[216:219]
    v_mfma_f32_16x16x32_bf16 v[220:223], v[232:235], v[60:63], v[220:223]
    s_waitcnt lgkmcnt(2)
    v_mfma_f32_16x16x32_bf16 v[208:211], v[236:239], v[64:67], v[208:211]
    ds_read_b64_tr_b16 v[224:225], v247 offset:40960
    v_mfma_f32_16x16x32_bf16 v[212:215], v[236:239], v[68:71], v[212:215]
    ds_read_b64_tr_b16 v[226:227], v247 offset:41216
    v_mfma_f32_16x16x32_bf16 v[216:219], v[236:239], v[72:75], v[216:219]
    v_mfma_f32_16x16x32_bf16 v[220:223], v[236:239], v[76:79], v[220:223]
    s_waitcnt lgkmcnt(2)
    v_mfma_f32_16x16x32_bf16 v[208:211], v[240:243], v[80:83], v[208:211]
    s_waitcnt lgkmcnt(0)
    s_barrier
    ds_read_b64_tr_b16 v[228:229], v253 offset:49152
    v_mfma_f32_16x16x32_bf16 v[212:215], v[240:243], v[84:87], v[212:215]
    ds_read_b64_tr_b16 v[230:231], v253 offset:49664
    v_mfma_f32_16x16x32_bf16 v[216:219], v[240:243], v[88:91], v[216:219]
    v_mfma_f32_16x16x32_bf16 v[220:223], v[240:243], v[92:95], v[220:223]
    v_mfma_f32_16x16x32_bf16 v[208:211], v[224:227], v[96:99], v[208:211]
    ds_read_b64_tr_b16 v[232:233], v244 offset:49152
    v_mfma_f32_16x16x32_bf16 v[212:215], v[224:227], v[100:103], v[212:215]
    ds_read_b64_tr_b16 v[234:235], v244 offset:49664
    v_mfma_f32_16x16x32_bf16 v[216:219], v[224:227], v[104:107], v[216:219]
    v_mfma_f32_16x16x32_bf16 v[220:223], v[224:227], v[108:111], v[220:223]
    s_waitcnt lgkmcnt(2)
    v_mfma_f32_16x16x32_bf16 v[144:147], v[228:231], v[0:3], 0
    ds_read_b64_tr_b16 v[236:237], v253 offset:53248
    v_mfma_f32_16x16x32_bf16 v[148:151], v[228:231], v[4:7], 0
    ds_read_b64_tr_b16 v[238:239], v253 offset:53760
    v_mfma_f32_16x16x32_bf16 v[152:155], v[228:231], v[8:11], 0
    v_mfma_f32_16x16x32_bf16 v[156:159], v[228:231], v[12:15], 0
    s_waitcnt lgkmcnt(2)
    v_mfma_f32_16x16x32_bf16 v[160:163], v[232:235], v[0:3], 0
    ds_read_b64_tr_b16 v[240:241], v244 offset:53248
    v_mfma_f32_16x16x32_bf16 v[164:167], v[232:235], v[4:7], 0
    ds_read_b64_tr_b16 v[242:243], v244 offset:53760
    v_mfma_f32_16x16x32_bf16 v[168:171], v[232:235], v[8:11], 0
    v_mfma_f32_16x16x32_bf16 v[172:175], v[232:235], v[12:15], 0
    s_waitcnt lgkmcnt(2)
    v_mfma_f32_16x16x32_bf16 v[144:147], v[236:239], v[16:19], v[144:147]
    ds_read_b64_tr_b16 v[224:225], v253 offset:57344
    v_mfma_f32_16x16x32_bf16 v[148:151], v[236:239], v[20:23], v[148:151]
    ds_read_b64_tr_b16 v[226:227], v253 offset:57856
    v_mfma_f32_16x16x32_bf16 v[152:155], v[236:239], v[24:27], v[152:155]
    v_mfma_f32_16x16x32_bf16 v[156:159], v[236:239], v[28:31], v[156:159]
    s_waitcnt lgkmcnt(2)
    v_mfma_f32_16x16x32_bf16 v[160:163], v[240:243], v[16:19], v[160:163]
    ds_read_b64_tr_b16 v[228:229], v244 offset:57344
    v_mfma_f32_16x16x32_bf16 v[164:167], v[240:243], v[20:23], v[164:167]
    ds_read_b64_tr_b16 v[230:231], v244 offset:57856
    v_mfma_f32_16x16x32_bf16 v[168:171], v[240:243], v[24:27], v[168:171]
    v_mfma_f32_16x16x32_bf16 v[172:175], v[240:243], v[28:31], v[172:175]
    s_waitcnt lgkmcnt(2)
    v_mfma_f32_16x16x32_bf16 v[144:147], v[224:227], v[32:35], v[144:147]
    ds_read_b64_tr_b16 v[232:233], v253 offset:61440
    v_mfma_f32_16x16x32_bf16 v[148:151], v[224:227], v[36:39], v[148:151]
    ds_read_b64_tr_b16 v[234:235], v253 offset:61952
    v_mfma_f32_16x16x32_bf16 v[152:155], v[224:227], v[40:43], v[152:155]
    v_mfma_f32_16x16x32_bf16 v[156:159], v[224:227], v[44:47], v[156:159]
    s_waitcnt lgkmcnt(2)
    v_mfma_f32_16x16x32_bf16 v[160:163], v[228:231], v[32:35], v[160:163]
    ds_read_b64_tr_b16 v[236:237], v244 offset:61440
    v_mfma_f32_16x16x32_bf16 v[164:167], v[228:231], v[36:39], v[164:167]
    ds_read_b64_tr_b16 v[238:239], v244 offset:61952
    v_mfma_f32_16x16x32_bf16 v[168:171], v[228:231], v[40:43], v[168:171]
    v_mfma_f32_16x16x32_bf16 v[172:175], v[228:231], v[44:47], v[172:175]
    s_waitcnt lgkmcnt(2)
    v_mfma_f32_16x16x32_bf16 v[144:147], v[232:235], v[48:51], v[144:147]
    ds_read_b64_tr_b16 v[240:241], v245 offset:0
    v_mfma_f32_16x16x32_bf16 v[148:151], v[232:235], v[52:55], v[148:151]
    ds_read_b64_tr_b16 v[242:243], v245 offset:512
    v_mfma_f32_16x16x32_bf16 v[152:155], v[232:235], v[56:59], v[152:155]
    v_mfma_f32_16x16x32_bf16 v[156:159], v[232:235], v[60:63], v[156:159]
    s_waitcnt lgkmcnt(2)
    v_mfma_f32_16x16x32_bf16 v[160:163], v[236:239], v[48:51], v[160:163]
    ds_read_b64_tr_b16 v[224:225], v246 offset:0
    v_mfma_f32_16x16x32_bf16 v[164:167], v[236:239], v[52:55], v[164:167]
    ds_read_b64_tr_b16 v[226:227], v246 offset:512
    v_mfma_f32_16x16x32_bf16 v[168:171], v[236:239], v[56:59], v[168:171]
    v_mfma_f32_16x16x32_bf16 v[172:175], v[236:239], v[60:63], v[172:175]
    s_waitcnt lgkmcnt(2)
    v_mfma_f32_16x16x32_bf16 v[144:147], v[240:243], v[64:67], v[144:147]
    ds_read_b64_tr_b16 v[228:229], v245 offset:4096
    v_mfma_f32_16x16x32_bf16 v[148:151], v[240:243], v[68:71], v[148:151]
    ds_read_b64_tr_b16 v[230:231], v245 offset:4608
    v_mfma_f32_16x16x32_bf16 v[152:155], v[240:243], v[72:75], v[152:155]
    v_mfma_f32_16x16x32_bf16 v[156:159], v[240:243], v[76:79], v[156:159]
    s_waitcnt lgkmcnt(2)
    v_mfma_f32_16x16x32_bf16 v[160:163], v[224:227], v[64:67], v[160:163]
    ds_read_b64_tr_b16 v[232:233], v246 offset:4096
    v_mfma_f32_16x16x32_bf16 v[164:167], v[224:227], v[68:71], v[164:167]
    ds_read_b64_tr_b16 v[234:235], v246 offset:4608
    v_mfma_f32_16x16x32_bf16 v[168:171], v[224:227], v[72:75], v[168:171]
    v_mfma_f32_16x16x32_bf16 v[172:175], v[224:227], v[76:79], v[172:175]
    s_waitcnt lgkmcnt(2)
    v_mfma_f32_16x16x32_bf16 v[144:147], v[228:231], v[80:83], v[144:147]
    ds_read_b64_tr_b16 v[236:237], v245 offset:8192
    v_mfma_f32_16x16x32_bf16 v[148:151], v[228:231], v[84:87], v[148:151]
    ds_read_b64_tr_b16 v[238:239], v245 offset:8704
    v_mfma_f32_16x16x32_bf16 v[152:155], v[228:231], v[88:91], v[152:155]
    v_mfma_f32_16x16x32_bf16 v[156:159], v[228:231], v[92:95], v[156:159]
    s_waitcnt lgkmcnt(2)
    v_mfma_f32_16x16x32_bf16 v[160:163], v[232:235], v[80:83], v[160:163]
    ds_read_b64_tr_b16 v[240:241], v246 offset:8192
    v_mfma_f32_16x16x32_bf16 v[164:167], v[232:235], v[84:87], v[164:167]
    ds_read_b64_tr_b16 v[242:243], v246 offset:8704
    v_mfma_f32_16x16x32_bf16 v[168:171], v[232:235], v[88:91], v[168:171]
    v_mfma_f32_16x16x32_bf16 v[172:175], v[232:235], v[92:95], v[172:175]
    s_waitcnt lgkmcnt(2)
    v_mfma_f32_16x16x32_bf16 v[144:147], v[236:239], v[96:99], v[144:147]
    s_waitcnt lgkmcnt(0)
    s_barrier
    ds_read_b64_tr_b16 v[224:225], v245 offset:12288
    v_mfma_f32_16x16x32_bf16 v[148:151], v[236:239], v[100:103], v[148:151]
    ds_read_b64_tr_b16 v[226:227], v245 offset:12800
    v_mfma_f32_16x16x32_bf16 v[152:155], v[236:239], v[104:107], v[152:155]
    v_mfma_f32_16x16x32_bf16 v[156:159], v[236:239], v[108:111], v[156:159]
    v_mfma_f32_16x16x32_bf16 v[160:163], v[240:243], v[96:99], v[160:163]
    ds_read_b64_tr_b16 v[228:229], v246 offset:12288
    v_mfma_f32_16x16x32_bf16 v[164:167], v[240:243], v[100:103], v[164:167]
    ds_read_b64_tr_b16 v[230:231], v246 offset:12800
    v_mfma_f32_16x16x32_bf16 v[168:171], v[240:243], v[104:107], v[168:171]
    v_mfma_f32_16x16x32_bf16 v[172:175], v[240:243], v[108:111], v[172:175]
    v_add_u32 v248, 49152, v248
    v_add_u32 v249, 49152, v249
    s_waitcnt lgkmcnt(2)
    v_mfma_f32_16x16x32_bf16 v[176:179], v[224:227], v[0:3], 0
    ds_read_b64_tr_b16 v[232:233], v245 offset:16384
    v_mfma_f32_16x16x32_bf16 v[180:183], v[224:227], v[4:7], 0
    ds_read_b64_tr_b16 v[234:235], v245 offset:16896
    v_mfma_f32_16x16x32_bf16 v[184:187], v[224:227], v[8:11], 0
    v_mfma_f32_16x16x32_bf16 v[188:191], v[224:227], v[12:15], 0
    s_waitcnt lgkmcnt(2)
    v_mfma_f32_16x16x32_bf16 v[192:195], v[228:231], v[0:3], 0
    ds_read_b64_tr_b16 v[236:237], v246 offset:16384
    v_mfma_f32_16x16x32_bf16 v[196:199], v[228:231], v[4:7], 0
    ds_read_b64_tr_b16 v[238:239], v246 offset:16896
    v_mfma_f32_16x16x32_bf16 v[200:203], v[228:231], v[8:11], 0
    v_mfma_f32_16x16x32_bf16 v[204:207], v[228:231], v[12:15], 0
    s_waitcnt lgkmcnt(2)
    v_mfma_f32_16x16x32_bf16 v[176:179], v[232:235], v[16:19], v[176:179]
    ds_read_b64_tr_b16 v[240:241], v245 offset:20480
    v_mfma_f32_16x16x32_bf16 v[180:183], v[232:235], v[20:23], v[180:183]
    ds_read_b64_tr_b16 v[242:243], v245 offset:20992
    v_mfma_f32_16x16x32_bf16 v[184:187], v[232:235], v[24:27], v[184:187]
    v_mfma_f32_16x16x32_bf16 v[188:191], v[232:235], v[28:31], v[188:191]
    s_waitcnt lgkmcnt(2)
    v_mfma_f32_16x16x32_bf16 v[192:195], v[236:239], v[16:19], v[192:195]
    ds_read_b64_tr_b16 v[224:225], v246 offset:20480
    v_mfma_f32_16x16x32_bf16 v[196:199], v[236:239], v[20:23], v[196:199]
    ds_read_b64_tr_b16 v[226:227], v246 offset:20992
    ds_read_b128 v[0:3], v249 offset:0
    v_mfma_f32_16x16x32_bf16 v[200:203], v[236:239], v[24:27], v[200:203]
    ds_read_b128 v[4:7], v249 offset:2048
    v_mfma_f32_16x16x32_bf16 v[204:207], v[236:239], v[28:31], v[204:207]
    ds_read_b128 v[8:11], v249 offset:4096
    s_waitcnt lgkmcnt(5)
    v_mfma_f32_16x16x32_bf16 v[176:179], v[240:243], v[32:35], v[176:179]
    ds_read_b64_tr_b16 v[228:229], v245 offset:24576
    v_mfma_f32_16x16x32_bf16 v[180:183], v[240:243], v[36:39], v[180:183]
    ds_read_b64_tr_b16 v[230:231], v245 offset:25088
    ds_read_b128 v[12:15], v249 offset:6144
    v_mfma_f32_16x16x32_bf16 v[184:187], v[240:243], v[40:43], v[184:187]
    v_mfma_f32_16x16x32_bf16 v[188:191], v[240:243], v[44:47], v[188:191]
    s_waitcnt lgkmcnt(6)
    v_mfma_f32_16x16x32_bf16 v[192:195], v[224:227], v[32:35], v[192:195]
    ds_read_b64_tr_b16 v[232:233], v246 offset:24576
    v_mfma_f32_16x16x32_bf16 v[196:199], v[224:227], v[36:39], v[196:199]
    ds_read_b64_tr_b16 v[234:235], v246 offset:25088
    ds_read_b128 v[16:19], v248 offset:16384
    v_mfma_f32_16x16x32_bf16 v[200:203], v[224:227], v[40:43], v[200:203]
    ds_read_b128 v[20:23], v248 offset:18432
    v_mfma_f32_16x16x32_bf16 v[204:207], v[224:227], v[44:47], v[204:207]
    ds_read_b128 v[24:27], v248 offset:20480
    s_waitcnt lgkmcnt(6)
    v_mfma_f32_16x16x32_bf16 v[176:179], v[228:231], v[48:51], v[176:179]
    ds_read_b64_tr_b16 v[236:237], v245 offset:28672
    v_mfma_f32_16x16x32_bf16 v[180:183], v[228:231], v[52:55], v[180:183]
    ds_read_b64_tr_b16 v[238:239], v245 offset:29184
    ds_read_b128 v[28:31], v248 offset:22528
    v_mfma_f32_16x16x32_bf16 v[184:187], v[228:231], v[56:59], v[184:187]
    v_mfma_f32_16x16x32_bf16 v[188:191], v[228:231], v[60:63], v[188:191]
    s_waitcnt lgkmcnt(6)
    v_mfma_f32_16x16x32_bf16 v[192:195], v[232:235], v[48:51], v[192:195]
    ds_read_b64_tr_b16 v[240:241], v246 offset:28672
    v_mfma_f32_16x16x32_bf16 v[196:199], v[232:235], v[52:55], v[196:199]
    ds_read_b64_tr_b16 v[242:243], v246 offset:29184
    ds_read_b128 v[32:35], v249 offset:16384
    v_mfma_f32_16x16x32_bf16 v[200:203], v[232:235], v[56:59], v[200:203]
    ds_read_b128 v[36:39], v249 offset:18432
    v_mfma_f32_16x16x32_bf16 v[204:207], v[232:235], v[60:63], v[204:207]
    ds_read_b128 v[40:43], v249 offset:20480
    s_waitcnt lgkmcnt(6)
    v_mfma_f32_16x16x32_bf16 v[176:179], v[236:239], v[64:67], v[176:179]
    ds_read_b64_tr_b16 v[224:225], v253 offset:0
    v_mfma_f32_16x16x32_bf16 v[180:183], v[236:239], v[68:71], v[180:183]
    ds_read_b64_tr_b16 v[226:227], v253 offset:512
    ds_read_b128 v[44:47], v249 offset:22528
    v_mfma_f32_16x16x32_bf16 v[184:187], v[236:239], v[72:75], v[184:187]
    v_mfma_f32_16x16x32_bf16 v[188:191], v[236:239], v[76:79], v[188:191]
    s_waitcnt lgkmcnt(6)
    v_mfma_f32_16x16x32_bf16 v[192:195], v[240:243], v[64:67], v[192:195]
    ds_read_b64_tr_b16 v[228:229], v244 offset:0
    v_mfma_f32_16x16x32_bf16 v[196:199], v[240:243], v[68:71], v[196:199]
    ds_read_b64_tr_b16 v[230:231], v244 offset:512
    ds_read_b128 v[48:51], v248 offset:32768
    v_mfma_f32_16x16x32_bf16 v[200:203], v[240:243], v[72:75], v[200:203]
    ds_read_b128 v[52:55], v248 offset:34816
    v_mfma_f32_16x16x32_bf16 v[204:207], v[240:243], v[76:79], v[204:207]
    ds_read_b128 v[56:59], v248 offset:36864
    s_waitcnt lgkmcnt(6)
    v_mfma_f32_16x16x32_bf16 v[176:179], v[224:227], v[80:83], v[176:179]
    ds_read_b64_tr_b16 v[232:233], v253 offset:4096
    v_mfma_f32_16x16x32_bf16 v[180:183], v[224:227], v[84:87], v[180:183]
    ds_read_b64_tr_b16 v[234:235], v253 offset:4608
    ds_read_b128 v[60:63], v248 offset:38912
    v_mfma_f32_16x16x32_bf16 v[184:187], v[224:227], v[88:91], v[184:187]
    v_mfma_f32_16x16x32_bf16 v[188:191], v[224:227], v[92:95], v[188:191]
    s_waitcnt lgkmcnt(6)
    v_mfma_f32_16x16x32_bf16 v[192:195], v[228:231], v[80:83], v[192:195]
    ds_read_b64_tr_b16 v[236:237], v244 offset:4096
    v_mfma_f32_16x16x32_bf16 v[196:199], v[228:231], v[84:87], v[196:199]
    ds_read_b64_tr_b16 v[238:239], v244 offset:4608
    ds_read_b128 v[64:67], v249 offset:32768
    v_mfma_f32_16x16x32_bf16 v[200:203], v[228:231], v[88:91], v[200:203]
    ds_read_b128 v[68:71], v249 offset:34816
    v_mfma_f32_16x16x32_bf16 v[204:207], v[228:231], v[92:95], v[204:207]
    ds_read_b128 v[72:75], v249 offset:36864
    s_waitcnt lgkmcnt(6)
    v_mfma_f32_16x16x32_bf16 v[176:179], v[232:235], v[96:99], v[176:179]
    s_waitcnt lgkmcnt(3)
    s_barrier
    ds_read_b64_tr_b16 v[240:241], v253 offset:8192
    v_mfma_f32_16x16x32_bf16 v[180:183], v[232:235], v[100:103], v[180:183]
    ds_read_b64_tr_b16 v[242:243], v253 offset:8704
    ds_read_b128 v[76:79], v249 offset:38912
    v_mfma_f32_16x16x32_bf16 v[184:187], v[232:235], v[104:107], v[184:187]
    v_mfma_f32_16x16x32_bf16 v[188:191], v[232:235], v[108:111], v[188:191]
    v_mfma_f32_16x16x32_bf16 v[192:195], v[236:239], v[96:99], v[192:195]
    ds_read_b64_tr_b16 v[224:225], v244 offset:8192
    v_mfma_f32_16x16x32_bf16 v[196:199], v[236:239], v[100:103], v[196:199]
    ds_read_b64_tr_b16 v[226:227], v244 offset:8704
    ds_read_b128 v[80:83], v248 offset:49152
    v_mfma_f32_16x16x32_bf16 v[200:203], v[236:239], v[104:107], v[200:203]
    ds_read_b128 v[84:87], v248 offset:51200
    v_mfma_f32_16x16x32_bf16 v[204:207], v[236:239], v[108:111], v[204:207]
    ds_read_b128 v[88:91], v248 offset:53248
    s_waitcnt lgkmcnt(6)
    v_mfma_f32_16x16x32_bf16 v[112:115], v[240:243], v[0:3], v[112:115]
    ds_read_b64_tr_b16 v[228:229], v253 offset:12288
    v_mfma_f32_16x16x32_bf16 v[116:119], v[240:243], v[4:7], v[116:119]
    ds_read_b64_tr_b16 v[230:231], v253 offset:12800
    ds_read_b128 v[92:95], v248 offset:55296
    v_mfma_f32_16x16x32_bf16 v[120:123], v[240:243], v[8:11], v[120:123]
    v_mfma_f32_16x16x32_bf16 v[124:127], v[240:243], v[12:15], v[124:127]
    s_waitcnt lgkmcnt(6)
    v_mfma_f32_16x16x32_bf16 v[128:131], v[224:227], v[0:3], v[128:131]
    ds_read_b64_tr_b16 v[232:233], v244 offset:12288
    v_mfma_f32_16x16x32_bf16 v[132:135], v[224:227], v[4:7], v[132:135]
    ds_read_b64_tr_b16 v[234:235], v244 offset:12800
    ds_read_b128 v[96:99], v249 offset:49152
    v_mfma_f32_16x16x32_bf16 v[136:139], v[224:227], v[8:11], v[136:139]
    ds_read_b128 v[100:103], v249 offset:51200
    v_mfma_f32_16x16x32_bf16 v[140:143], v[224:227], v[12:15], v[140:143]
    ds_read_b128 v[104:107], v249 offset:53248
    s_waitcnt lgkmcnt(6)
    v_mfma_f32_16x16x32_bf16 v[112:115], v[228:231], v[16:19], v[112:115]
    ds_read_b64_tr_b16 v[236:237], v253 offset:16384
    v_mfma_f32_16x16x32_bf16 v[116:119], v[228:231], v[20:23], v[116:119]
    ds_read_b64_tr_b16 v[238:239], v253 offset:16896
    ds_read_b128 v[108:111], v249 offset:55296
    v_mfma_f32_16x16x32_bf16 v[120:123], v[228:231], v[24:27], v[120:123]
    v_mfma_f32_16x16x32_bf16 v[124:127], v[228:231], v[28:31], v[124:127]
    s_waitcnt lgkmcnt(6)
    v_mfma_f32_16x16x32_bf16 v[128:131], v[232:235], v[16:19], v[128:131]
    ds_read_b64_tr_b16 v[240:241], v244 offset:16384
    v_mfma_f32_16x16x32_bf16 v[132:135], v[232:235], v[20:23], v[132:135]
    ds_read_b64_tr_b16 v[242:243], v244 offset:16896
    v_mfma_f32_16x16x32_bf16 v[136:139], v[232:235], v[24:27], v[136:139]
    v_mfma_f32_16x16x32_bf16 v[140:143], v[232:235], v[28:31], v[140:143]
    s_waitcnt lgkmcnt(3)
    v_mfma_f32_16x16x32_bf16 v[112:115], v[236:239], v[32:35], v[112:115]
    ds_read_b64_tr_b16 v[224:225], v253 offset:20480
    v_mfma_f32_16x16x32_bf16 v[116:119], v[236:239], v[36:39], v[116:119]
    ds_read_b64_tr_b16 v[226:227], v253 offset:20992
    v_mfma_f32_16x16x32_bf16 v[120:123], v[236:239], v[40:43], v[120:123]
    v_mfma_f32_16x16x32_bf16 v[124:127], v[236:239], v[44:47], v[124:127]
    s_waitcnt lgkmcnt(2)
    v_mfma_f32_16x16x32_bf16 v[128:131], v[240:243], v[32:35], v[128:131]
    ds_read_b64_tr_b16 v[228:229], v244 offset:20480
    v_mfma_f32_16x16x32_bf16 v[132:135], v[240:243], v[36:39], v[132:135]
    ds_read_b64_tr_b16 v[230:231], v244 offset:20992
    v_mfma_f32_16x16x32_bf16 v[136:139], v[240:243], v[40:43], v[136:139]
    v_mfma_f32_16x16x32_bf16 v[140:143], v[240:243], v[44:47], v[140:143]
    s_waitcnt lgkmcnt(2)
    v_mfma_f32_16x16x32_bf16 v[112:115], v[224:227], v[48:51], v[112:115]
    ds_read_b64_tr_b16 v[232:233], v253 offset:24576
    v_mfma_f32_16x16x32_bf16 v[116:119], v[224:227], v[52:55], v[116:119]
    ds_read_b64_tr_b16 v[234:235], v253 offset:25088
    v_mfma_f32_16x16x32_bf16 v[120:123], v[224:227], v[56:59], v[120:123]
    v_mfma_f32_16x16x32_bf16 v[124:127], v[224:227], v[60:63], v[124:127]
    s_waitcnt lgkmcnt(2)
    v_mfma_f32_16x16x32_bf16 v[128:131], v[228:231], v[48:51], v[128:131]
    ds_read_b64_tr_b16 v[236:237], v244 offset:24576
    v_mfma_f32_16x16x32_bf16 v[132:135], v[228:231], v[52:55], v[132:135]
    ds_read_b64_tr_b16 v[238:239], v244 offset:25088
    v_mfma_f32_16x16x32_bf16 v[136:139], v[228:231], v[56:59], v[136:139]
    v_mfma_f32_16x16x32_bf16 v[140:143], v[228:231], v[60:63], v[140:143]
    s_waitcnt lgkmcnt(2)
    v_mfma_f32_16x16x32_bf16 v[112:115], v[232:235], v[64:67], v[112:115]
    ds_read_b64_tr_b16 v[240:241], v253 offset:28672
    v_mfma_f32_16x16x32_bf16 v[116:119], v[232:235], v[68:71], v[116:119]
    ds_read_b64_tr_b16 v[242:243], v253 offset:29184
    v_mfma_f32_16x16x32_bf16 v[120:123], v[232:235], v[72:75], v[120:123]
    v_mfma_f32_16x16x32_bf16 v[124:127], v[232:235], v[76:79], v[124:127]
    s_waitcnt lgkmcnt(2)
    v_mfma_f32_16x16x32_bf16 v[128:131], v[236:239], v[64:67], v[128:131]
    ds_read_b64_tr_b16 v[224:225], v244 offset:28672
    v_mfma_f32_16x16x32_bf16 v[132:135], v[236:239], v[68:71], v[132:135]
    ds_read_b64_tr_b16 v[226:227], v244 offset:29184
    v_mfma_f32_16x16x32_bf16 v[136:139], v[236:239], v[72:75], v[136:139]
    v_mfma_f32_16x16x32_bf16 v[140:143], v[236:239], v[76:79], v[140:143]
    s_waitcnt lgkmcnt(2)
    v_mfma_f32_16x16x32_bf16 v[112:115], v[240:243], v[80:83], v[112:115]
    ds_read_b64_tr_b16 v[228:229], v253 offset:32768
    v_mfma_f32_16x16x32_bf16 v[116:119], v[240:243], v[84:87], v[116:119]
    ds_read_b64_tr_b16 v[230:231], v253 offset:33280
    v_mfma_f32_16x16x32_bf16 v[120:123], v[240:243], v[88:91], v[120:123]
    v_mfma_f32_16x16x32_bf16 v[124:127], v[240:243], v[92:95], v[124:127]
    s_waitcnt lgkmcnt(2)
    v_mfma_f32_16x16x32_bf16 v[128:131], v[224:227], v[80:83], v[128:131]
    ds_read_b64_tr_b16 v[232:233], v244 offset:32768
    v_mfma_f32_16x16x32_bf16 v[132:135], v[224:227], v[84:87], v[132:135]
    ds_read_b64_tr_b16 v[234:235], v244 offset:33280
    v_mfma_f32_16x16x32_bf16 v[136:139], v[224:227], v[88:91], v[136:139]
    v_mfma_f32_16x16x32_bf16 v[140:143], v[224:227], v[92:95], v[140:143]
    s_waitcnt lgkmcnt(2)
    v_mfma_f32_16x16x32_bf16 v[112:115], v[228:231], v[96:99], v[112:115]
    s_waitcnt lgkmcnt(0)
    s_barrier
    ds_read_b64_tr_b16 v[236:237], v247 offset:49152
    v_mfma_f32_16x16x32_bf16 v[116:119], v[228:231], v[100:103], v[116:119]
    ds_read_b64_tr_b16 v[238:239], v247 offset:49408
    v_mfma_f32_16x16x32_bf16 v[120:123], v[228:231], v[104:107], v[120:123]
    v_mfma_f32_16x16x32_bf16 v[124:127], v[228:231], v[108:111], v[124:127]
    v_mfma_f32_16x16x32_bf16 v[128:131], v[232:235], v[96:99], v[128:131]
    ds_read_b64_tr_b16 v[240:241], v247 offset:51200
    v_mfma_f32_16x16x32_bf16 v[132:135], v[232:235], v[100:103], v[132:135]
    ds_read_b64_tr_b16 v[242:243], v247 offset:51456
    v_mfma_f32_16x16x32_bf16 v[136:139], v[232:235], v[104:107], v[136:139]
    v_mfma_f32_16x16x32_bf16 v[140:143], v[232:235], v[108:111], v[140:143]
    s_waitcnt lgkmcnt(2)
    v_mfma_f32_16x16x32_bf16 v[208:211], v[236:239], v[0:3], v[208:211]
    ds_read_b64_tr_b16 v[224:225], v247 offset:53248
    v_mfma_f32_16x16x32_bf16 v[212:215], v[236:239], v[4:7], v[212:215]
    ds_read_b64_tr_b16 v[226:227], v247 offset:53504
    v_mfma_f32_16x16x32_bf16 v[216:219], v[236:239], v[8:11], v[216:219]
    v_mfma_f32_16x16x32_bf16 v[220:223], v[236:239], v[12:15], v[220:223]
    s_waitcnt lgkmcnt(2)
    v_mfma_f32_16x16x32_bf16 v[208:211], v[240:243], v[16:19], v[208:211]
    ds_read_b64_tr_b16 v[228:229], v247 offset:55296
    v_mfma_f32_16x16x32_bf16 v[212:215], v[240:243], v[20:23], v[212:215]
    ds_read_b64_tr_b16 v[230:231], v247 offset:55552
    v_mfma_f32_16x16x32_bf16 v[216:219], v[240:243], v[24:27], v[216:219]
    v_mfma_f32_16x16x32_bf16 v[220:223], v[240:243], v[28:31], v[220:223]
    s_waitcnt lgkmcnt(2)
    v_mfma_f32_16x16x32_bf16 v[208:211], v[224:227], v[32:35], v[208:211]
    ds_read_b64_tr_b16 v[232:233], v247 offset:57344
    v_mfma_f32_16x16x32_bf16 v[212:215], v[224:227], v[36:39], v[212:215]
    ds_read_b64_tr_b16 v[234:235], v247 offset:57600
    v_cvt_pk_bf16_f32 v112, v112, v113
    v_cvt_pk_bf16_f32 v113, v114, v115
    v_mfma_f32_16x16x32_bf16 v[216:219], v[224:227], v[40:43], v[216:219]
    ds_write_b64 v250, v[112:113] offset:0
    v_cvt_pk_bf16_f32 v116, v116, v117
    v_mfma_f32_16x16x32_bf16 v[220:223], v[224:227], v[44:47], v[220:223]
    v_cvt_pk_bf16_f32 v117, v118, v119
    ds_write_b64 v250, v[116:117] offset:2048
    s_waitcnt lgkmcnt(4)
    v_mfma_f32_16x16x32_bf16 v[208:211], v[228:231], v[48:51], v[208:211]
    ds_read_b64_tr_b16 v[236:237], v247 offset:59392
    v_mfma_f32_16x16x32_bf16 v[212:215], v[228:231], v[52:55], v[212:215]
    ds_read_b64_tr_b16 v[238:239], v247 offset:59648
    v_cvt_pk_bf16_f32 v120, v120, v121
    v_cvt_pk_bf16_f32 v121, v122, v123
    v_mfma_f32_16x16x32_bf16 v[216:219], v[228:231], v[56:59], v[216:219]
    ds_write_b64 v250, v[120:121] offset:4096
    v_cvt_pk_bf16_f32 v124, v124, v125
    v_mfma_f32_16x16x32_bf16 v[220:223], v[228:231], v[60:63], v[220:223]
    v_cvt_pk_bf16_f32 v125, v126, v127
    ds_write_b64 v250, v[124:125] offset:6144
    s_waitcnt lgkmcnt(6)
    v_mfma_f32_16x16x32_bf16 v[208:211], v[232:235], v[64:67], v[208:211]
    ds_read_b64_tr_b16 v[240:241], v247 offset:61440
    v_mfma_f32_16x16x32_bf16 v[212:215], v[232:235], v[68:71], v[212:215]
    ds_read_b64_tr_b16 v[242:243], v247 offset:61696
    v_cvt_pk_bf16_f32 v128, v128, v129
    v_cvt_pk_bf16_f32 v129, v130, v131
    v_mfma_f32_16x16x32_bf16 v[216:219], v[232:235], v[72:75], v[216:219]
    ds_write_b64 v251, v[128:129] offset:0
    v_cvt_pk_bf16_f32 v132, v132, v133
    v_mfma_f32_16x16x32_bf16 v[220:223], v[232:235], v[76:79], v[220:223]
    v_cvt_pk_bf16_f32 v133, v134, v135
    ds_write_b64 v251, v[132:133] offset:2048
    s_waitcnt lgkmcnt(6)
    v_mfma_f32_16x16x32_bf16 v[208:211], v[236:239], v[80:83], v[208:211]
    ds_read_b64_tr_b16 v[224:225], v245 offset:0
    v_mfma_f32_16x16x32_bf16 v[212:215], v[236:239], v[84:87], v[212:215]
    ds_read_b64_tr_b16 v[226:227], v245 offset:512
    v_cvt_pk_bf16_f32 v136, v136, v137
    v_cvt_pk_bf16_f32 v137, v138, v139
    v_mfma_f32_16x16x32_bf16 v[216:219], v[236:239], v[88:91], v[216:219]
    ds_write_b64 v251, v[136:137] offset:4096
    v_cvt_pk_bf16_f32 v140, v140, v141
    v_mfma_f32_16x16x32_bf16 v[220:223], v[236:239], v[92:95], v[220:223]
    v_cvt_pk_bf16_f32 v141, v142, v143
    ds_write_b64 v251, v[140:141] offset:6144
    s_waitcnt lgkmcnt(6)
    v_mfma_f32_16x16x32_bf16 v[208:211], v[240:243], v[96:99], v[208:211]
    ds_read_b64_tr_b16 v[228:229], v246 offset:0
    v_mfma_f32_16x16x32_bf16 v[212:215], v[240:243], v[100:103], v[212:215]
    ds_read_b64_tr_b16 v[230:231], v246 offset:512
    v_mfma_f32_16x16x32_bf16 v[216:219], v[240:243], v[104:107], v[216:219]
    v_mfma_f32_16x16x32_bf16 v[220:223], v[240:243], v[108:111], v[220:223]
    s_waitcnt lgkmcnt(4)
    v_mfma_f32_16x16x32_bf16 v[144:147], v[224:227], v[0:3], v[144:147]
    s_waitcnt lgkmcnt(2)
    s_barrier
    ds_read_b64_tr_b16 v[232:233], v245 offset:4096
    v_mfma_f32_16x16x32_bf16 v[148:151], v[224:227], v[4:7], v[148:151]
    ds_read_b64_tr_b16 v[234:235], v245 offset:4608
    v_mfma_f32_16x16x32_bf16 v[152:155], v[224:227], v[8:11], v[152:155]
    v_mfma_f32_16x16x32_bf16 v[156:159], v[224:227], v[12:15], v[156:159]
    s_waitcnt lgkmcnt(2)
    v_mfma_f32_16x16x32_bf16 v[160:163], v[228:231], v[0:3], v[160:163]
    ds_read_b64_tr_b16 v[236:237], v246 offset:4096
    v_mfma_f32_16x16x32_bf16 v[164:167], v[228:231], v[4:7], v[164:167]
    ds_read_b64_tr_b16 v[238:239], v246 offset:4608
    v_cvt_pk_bf16_f32 v208, v208, v209
    v_cvt_pk_bf16_f32 v209, v210, v211
    v_mfma_f32_16x16x32_bf16 v[168:171], v[228:231], v[8:11], v[168:171]
    ds_write_b64 v252, v[208:209] offset:0
    v_cvt_pk_bf16_f32 v212, v212, v213
    v_mfma_f32_16x16x32_bf16 v[172:175], v[228:231], v[12:15], v[172:175]
    v_cvt_pk_bf16_f32 v213, v214, v215
    ds_write_b64 v252, v[212:213] offset:1024
    s_waitcnt lgkmcnt(4)
    v_mfma_f32_16x16x32_bf16 v[144:147], v[232:235], v[16:19], v[144:147]
    ds_read_b64_tr_b16 v[240:241], v245 offset:8192
    v_mfma_f32_16x16x32_bf16 v[148:151], v[232:235], v[20:23], v[148:151]
    ds_read_b64_tr_b16 v[242:243], v245 offset:8704
    v_cvt_pk_bf16_f32 v216, v216, v217
    v_cvt_pk_bf16_f32 v217, v218, v219
    v_mfma_f32_16x16x32_bf16 v[152:155], v[232:235], v[24:27], v[152:155]
    ds_write_b64 v252, v[216:217] offset:2048
    v_cvt_pk_bf16_f32 v220, v220, v221
    v_mfma_f32_16x16x32_bf16 v[156:159], v[232:235], v[28:31], v[156:159]
    v_cvt_pk_bf16_f32 v221, v222, v223
    ds_write_b64 v252, v[220:221] offset:3072
    s_waitcnt lgkmcnt(6)
    v_mfma_f32_16x16x32_bf16 v[160:163], v[236:239], v[16:19], v[160:163]
    ds_read_b64_tr_b16 v[224:225], v246 offset:8192
    v_mfma_f32_16x16x32_bf16 v[164:167], v[236:239], v[20:23], v[164:167]
    ds_read_b64_tr_b16 v[226:227], v246 offset:8704
    v_mfma_f32_16x16x32_bf16 v[168:171], v[236:239], v[24:27], v[168:171]
    v_mfma_f32_16x16x32_bf16 v[172:175], v[236:239], v[28:31], v[172:175]
    s_waitcnt lgkmcnt(4)
    v_mfma_f32_16x16x32_bf16 v[144:147], v[240:243], v[32:35], v[144:147]
    ds_read_b64_tr_b16 v[228:229], v253 offset:36864
    v_mfma_f32_16x16x32_bf16 v[148:151], v[240:243], v[36:39], v[148:151]
    ds_read_b64_tr_b16 v[230:231], v253 offset:37376
    v_mfma_f32_16x16x32_bf16 v[152:155], v[240:243], v[40:43], v[152:155]
    v_mfma_f32_16x16x32_bf16 v[156:159], v[240:243], v[44:47], v[156:159]
    s_waitcnt lgkmcnt(2)
    v_mfma_f32_16x16x32_bf16 v[160:163], v[224:227], v[32:35], v[160:163]
    ds_read_b64_tr_b16 v[232:233], v244 offset:36864
    v_mfma_f32_16x16x32_bf16 v[164:167], v[224:227], v[36:39], v[164:167]
    ds_read_b64_tr_b16 v[234:235], v244 offset:37376
    v_mfma_f32_16x16x32_bf16 v[168:171], v[224:227], v[40:43], v[168:171]
    v_mfma_f32_16x16x32_bf16 v[172:175], v[224:227], v[44:47], v[172:175]
    s_waitcnt lgkmcnt(2)
    v_mfma_f32_16x16x32_bf16 v[144:147], v[228:231], v[48:51], v[144:147]
    ds_read_b64_tr_b16 v[236:237], v253 offset:40960
    v_mfma_f32_16x16x32_bf16 v[148:151], v[228:231], v[52:55], v[148:151]
    ds_read_b64_tr_b16 v[238:239], v253 offset:41472
    v_mfma_f32_16x16x32_bf16 v[152:155], v[228:231], v[56:59], v[152:155]
    v_mfma_f32_16x16x32_bf16 v[156:159], v[228:231], v[60:63], v[156:159]
    s_waitcnt lgkmcnt(2)
    v_mfma_f32_16x16x32_bf16 v[160:163], v[232:235], v[48:51], v[160:163]
    ds_read_b64_tr_b16 v[240:241], v244 offset:40960
    v_mfma_f32_16x16x32_bf16 v[164:167], v[232:235], v[52:55], v[164:167]
    ds_read_b64_tr_b16 v[242:243], v244 offset:41472
    v_mfma_f32_16x16x32_bf16 v[168:171], v[232:235], v[56:59], v[168:171]
    v_mfma_f32_16x16x32_bf16 v[172:175], v[232:235], v[60:63], v[172:175]
    s_waitcnt lgkmcnt(2)
    v_mfma_f32_16x16x32_bf16 v[144:147], v[236:239], v[64:67], v[144:147]
    ds_read_b64_tr_b16 v[224:225], v253 offset:45056
    v_mfma_f32_16x16x32_bf16 v[148:151], v[236:239], v[68:71], v[148:151]
    ds_read_b64_tr_b16 v[226:227], v253 offset:45568
    v_mfma_f32_16x16x32_bf16 v[152:155], v[236:239], v[72:75], v[152:155]
    v_mfma_f32_16x16x32_bf16 v[156:159], v[236:239], v[76:79], v[156:159]
    s_waitcnt lgkmcnt(2)
    v_mfma_f32_16x16x32_bf16 v[160:163], v[240:243], v[64:67], v[160:163]
    ds_read_b64_tr_b16 v[228:229], v244 offset:45056
    v_mfma_f32_16x16x32_bf16 v[164:167], v[240:243], v[68:71], v[164:167]
    ds_read_b64_tr_b16 v[230:231], v244 offset:45568
    v_mfma_f32_16x16x32_bf16 v[168:171], v[240:243], v[72:75], v[168:171]
    v_mfma_f32_16x16x32_bf16 v[172:175], v[240:243], v[76:79], v[172:175]
    s_waitcnt lgkmcnt(2)
    v_mfma_f32_16x16x32_bf16 v[144:147], v[224:227], v[80:83], v[144:147]
    ds_read_b64_tr_b16 v[232:233], v245 offset:12288
    v_mfma_f32_16x16x32_bf16 v[148:151], v[224:227], v[84:87], v[148:151]
    ds_read_b64_tr_b16 v[234:235], v245 offset:12800
    v_mfma_f32_16x16x32_bf16 v[152:155], v[224:227], v[88:91], v[152:155]
    v_mfma_f32_16x16x32_bf16 v[156:159], v[224:227], v[92:95], v[156:159]
    s_waitcnt lgkmcnt(2)
    v_mfma_f32_16x16x32_bf16 v[160:163], v[228:231], v[80:83], v[160:163]
    ds_read_b64_tr_b16 v[236:237], v246 offset:12288
    v_mfma_f32_16x16x32_bf16 v[164:167], v[228:231], v[84:87], v[164:167]
    ds_read_b64_tr_b16 v[238:239], v246 offset:12800
    v_mfma_f32_16x16x32_bf16 v[168:171], v[228:231], v[88:91], v[168:171]
    v_mfma_f32_16x16x32_bf16 v[172:175], v[228:231], v[92:95], v[172:175]
    s_waitcnt lgkmcnt(2)
    v_mfma_f32_16x16x32_bf16 v[144:147], v[232:235], v[96:99], v[144:147]
    s_waitcnt lgkmcnt(0)
    s_barrier
    ds_read_b64_tr_b16 v[240:241], v245 offset:16384
    v_mfma_f32_16x16x32_bf16 v[148:151], v[232:235], v[100:103], v[148:151]
    ds_read_b64_tr_b16 v[242:243], v245 offset:16896
    v_mfma_f32_16x16x32_bf16 v[152:155], v[232:235], v[104:107], v[152:155]
    v_mfma_f32_16x16x32_bf16 v[156:159], v[232:235], v[108:111], v[156:159]
    v_mfma_f32_16x16x32_bf16 v[160:163], v[236:239], v[96:99], v[160:163]
    ds_read_b64_tr_b16 v[224:225], v245 offset:20480
    v_mfma_f32_16x16x32_bf16 v[164:167], v[236:239], v[100:103], v[164:167]
    ds_read_b64_tr_b16 v[226:227], v245 offset:20992
    v_mfma_f32_16x16x32_bf16 v[168:171], v[236:239], v[104:107], v[168:171]
    v_mfma_f32_16x16x32_bf16 v[172:175], v[236:239], v[108:111], v[172:175]
    s_waitcnt lgkmcnt(2)
    v_mfma_f32_16x16x32_bf16 v[176:179], v[240:243], v[0:3], v[176:179]
    ds_read_b64_tr_b16 v[228:229], v245 offset:24576
    v_mfma_f32_16x16x32_bf16 v[180:183], v[240:243], v[4:7], v[180:183]
    ds_read_b64_tr_b16 v[230:231], v245 offset:25088
    v_mfma_f32_16x16x32_bf16 v[184:187], v[240:243], v[8:11], v[184:187]
    v_mfma_f32_16x16x32_bf16 v[188:191], v[240:243], v[12:15], v[188:191]
    s_waitcnt lgkmcnt(2)
    v_mfma_f32_16x16x32_bf16 v[176:179], v[224:227], v[16:19], v[176:179]
    ds_read_b64_tr_b16 v[232:233], v245 offset:28672
    v_mfma_f32_16x16x32_bf16 v[180:183], v[224:227], v[20:23], v[180:183]
    ds_read_b64_tr_b16 v[234:235], v245 offset:29184
    v_mfma_f32_16x16x32_bf16 v[184:187], v[224:227], v[24:27], v[184:187]
    v_mfma_f32_16x16x32_bf16 v[188:191], v[224:227], v[28:31], v[188:191]
    s_waitcnt lgkmcnt(2)
    v_mfma_f32_16x16x32_bf16 v[176:179], v[228:231], v[32:35], v[176:179]
    ds_read_b64_tr_b16 v[236:237], v253 offset:0
    v_mfma_f32_16x16x32_bf16 v[180:183], v[228:231], v[36:39], v[180:183]
    ds_read_b64_tr_b16 v[238:239], v253 offset:512
    v_cvt_pk_bf16_f32 v144, v144, v145
    v_cvt_pk_bf16_f32 v145, v146, v147
    v_mfma_f32_16x16x32_bf16 v[184:187], v[228:231], v[40:43], v[184:187]
    ds_write_b64 v250, v[144:145] offset:16384
    v_cvt_pk_bf16_f32 v148, v148, v149
    v_mfma_f32_16x16x32_bf16 v[188:191], v[228:231], v[44:47], v[188:191]
    v_cvt_pk_bf16_f32 v149, v150, v151
    ds_write_b64 v250, v[148:149] offset:18432
    s_waitcnt lgkmcnt(4)
    v_mfma_f32_16x16x32_bf16 v[176:179], v[232:235], v[48:51], v[176:179]
    ds_read_b64_tr_b16 v[240:241], v253 offset:4096
    v_mfma_f32_16x16x32_bf16 v[180:183], v[232:235], v[52:55], v[180:183]
    ds_read_b64_tr_b16 v[242:243], v253 offset:4608
    v_cvt_pk_bf16_f32 v152, v152, v153
    v_cvt_pk_bf16_f32 v153, v154, v155
    v_mfma_f32_16x16x32_bf16 v[184:187], v[232:235], v[56:59], v[184:187]
    ds_write_b64 v250, v[152:153] offset:20480
    v_cvt_pk_bf16_f32 v156, v156, v157
    v_mfma_f32_16x16x32_bf16 v[188:191], v[232:235], v[60:63], v[188:191]
    v_cvt_pk_bf16_f32 v157, v158, v159
    ds_write_b64 v250, v[156:157] offset:22528
    s_waitcnt lgkmcnt(6)
    v_mfma_f32_16x16x32_bf16 v[176:179], v[236:239], v[64:67], v[176:179]
    ds_read_b64_tr_b16 v[224:225], v245 offset:32768
    v_mfma_f32_16x16x32_bf16 v[180:183], v[236:239], v[68:71], v[180:183]
    ds_read_b64_tr_b16 v[226:227], v245 offset:33280
    v_cvt_pk_bf16_f32 v160, v160, v161
    v_cvt_pk_bf16_f32 v161, v162, v163
    v_mfma_f32_16x16x32_bf16 v[184:187], v[236:239], v[72:75], v[184:187]
    ds_write_b64 v251, v[160:161] offset:16384
    v_cvt_pk_bf16_f32 v164, v164, v165
    v_mfma_f32_16x16x32_bf16 v[188:191], v[236:239], v[76:79], v[188:191]
    v_cvt_pk_bf16_f32 v165, v166, v167
    ds_write_b64 v251, v[164:165] offset:18432
    s_waitcnt lgkmcnt(6)
    v_mfma_f32_16x16x32_bf16 v[176:179], v[240:243], v[80:83], v[176:179]
    ds_read_b64_tr_b16 v[228:229], v246 offset:16384
    v_mfma_f32_16x16x32_bf16 v[180:183], v[240:243], v[84:87], v[180:183]
    ds_read_b64_tr_b16 v[230:231], v246 offset:16896
    v_cvt_pk_bf16_f32 v168, v168, v169
    v_cvt_pk_bf16_f32 v169, v170, v171
    v_mfma_f32_16x16x32_bf16 v[184:187], v[240:243], v[88:91], v[184:187]
    ds_write_b64 v251, v[168:169] offset:20480
    v_cvt_pk_bf16_f32 v172, v172, v173
    v_mfma_f32_16x16x32_bf16 v[188:191], v[240:243], v[92:95], v[188:191]
    v_cvt_pk_bf16_f32 v173, v174, v175
    ds_write_b64 v251, v[172:173] offset:22528
    s_waitcnt lgkmcnt(6)
    v_mfma_f32_16x16x32_bf16 v[176:179], v[224:227], v[96:99], v[176:179]
    s_waitcnt lgkmcnt(0)
    s_barrier
    ds_read_b64_tr_b16 v[232:233], v246 offset:20480
    v_mfma_f32_16x16x32_bf16 v[180:183], v[224:227], v[100:103], v[180:183]
    ds_read_b64_tr_b16 v[234:235], v246 offset:20992
    v_mfma_f32_16x16x32_bf16 v[184:187], v[224:227], v[104:107], v[184:187]
    v_mfma_f32_16x16x32_bf16 v[188:191], v[224:227], v[108:111], v[188:191]
    v_mfma_f32_16x16x32_bf16 v[192:195], v[228:231], v[0:3], v[192:195]
    ds_read_b64_tr_b16 v[236:237], v246 offset:24576
    v_mfma_f32_16x16x32_bf16 v[196:199], v[228:231], v[4:7], v[196:199]
    ds_read_b64_tr_b16 v[238:239], v246 offset:25088
    v_mfma_f32_16x16x32_bf16 v[200:203], v[228:231], v[8:11], v[200:203]
    v_mfma_f32_16x16x32_bf16 v[204:207], v[228:231], v[12:15], v[204:207]
    s_waitcnt lgkmcnt(2)
    v_mfma_f32_16x16x32_bf16 v[192:195], v[232:235], v[16:19], v[192:195]
    ds_read_b64_tr_b16 v[240:241], v246 offset:28672
    v_mfma_f32_16x16x32_bf16 v[196:199], v[232:235], v[20:23], v[196:199]
    ds_read_b64_tr_b16 v[242:243], v246 offset:29184
    v_mfma_f32_16x16x32_bf16 v[200:203], v[232:235], v[24:27], v[200:203]
    v_mfma_f32_16x16x32_bf16 v[204:207], v[232:235], v[28:31], v[204:207]
    s_waitcnt lgkmcnt(2)
    v_mfma_f32_16x16x32_bf16 v[192:195], v[236:239], v[32:35], v[192:195]
    ds_read_b64_tr_b16 v[224:225], v244 offset:0
    v_mfma_f32_16x16x32_bf16 v[196:199], v[236:239], v[36:39], v[196:199]
    ds_read_b64_tr_b16 v[226:227], v244 offset:512
    v_cvt_pk_bf16_f32 v176, v176, v177
    v_cvt_pk_bf16_f32 v177, v178, v179
    v_mfma_f32_16x16x32_bf16 v[200:203], v[236:239], v[40:43], v[200:203]
    ds_write_b64 v250, v[176:177] offset:0
    v_cvt_pk_bf16_f32 v180, v180, v181
    v_mfma_f32_16x16x32_bf16 v[204:207], v[236:239], v[44:47], v[204:207]
    v_cvt_pk_bf16_f32 v181, v182, v183
    ds_write_b64 v250, v[180:181] offset:2048
    s_waitcnt lgkmcnt(4)
    v_mfma_f32_16x16x32_bf16 v[192:195], v[240:243], v[48:51], v[192:195]
    ds_read_b64_tr_b16 v[228:229], v244 offset:4096
    v_mfma_f32_16x16x32_bf16 v[196:199], v[240:243], v[52:55], v[196:199]
    ds_read_b64_tr_b16 v[230:231], v244 offset:4608
    v_cvt_pk_bf16_f32 v184, v184, v185
    v_cvt_pk_bf16_f32 v185, v186, v187
    v_mfma_f32_16x16x32_bf16 v[200:203], v[240:243], v[56:59], v[200:203]
    ds_write_b64 v250, v[184:185] offset:4096
    v_cvt_pk_bf16_f32 v188, v188, v189
    v_mfma_f32_16x16x32_bf16 v[204:207], v[240:243], v[60:63], v[204:207]
    v_cvt_pk_bf16_f32 v189, v190, v191
    ds_write_b64 v250, v[188:189] offset:6144
    s_waitcnt lgkmcnt(6)
    v_mfma_f32_16x16x32_bf16 v[192:195], v[224:227], v[64:67], v[192:195]
    ds_read_b64_tr_b16 v[232:233], v246 offset:32768
    v_mfma_f32_16x16x32_bf16 v[196:199], v[224:227], v[68:71], v[196:199]
    ds_read_b64_tr_b16 v[234:235], v246 offset:33280
    v_mfma_f32_16x16x32_bf16 v[200:203], v[224:227], v[72:75], v[200:203]
    v_mfma_f32_16x16x32_bf16 v[204:207], v[224:227], v[76:79], v[204:207]
    s_waitcnt lgkmcnt(4)
    v_mfma_f32_16x16x32_bf16 v[192:195], v[228:231], v[80:83], v[192:195]
    v_mfma_f32_16x16x32_bf16 v[196:199], v[228:231], v[84:87], v[196:199]
    v_mfma_f32_16x16x32_bf16 v[200:203], v[228:231], v[88:91], v[200:203]
    v_mfma_f32_16x16x32_bf16 v[204:207], v[228:231], v[92:95], v[204:207]
    s_waitcnt lgkmcnt(0)
    v_mfma_f32_16x16x32_bf16 v[192:195], v[232:235], v[96:99], v[192:195]
    v_mfma_f32_16x16x32_bf16 v[196:199], v[232:235], v[100:103], v[196:199]
    v_mfma_f32_16x16x32_bf16 v[200:203], v[232:235], v[104:107], v[200:203]
    v_mfma_f32_16x16x32_bf16 v[204:207], v[232:235], v[108:111], v[204:207]
    s_nop 7
    v_cvt_pk_bf16_f32 v192, v192, v193
    v_cvt_pk_bf16_f32 v193, v194, v195
    ds_write_b64 v251, v[192:193] offset:0
    v_cvt_pk_bf16_f32 v196, v196, v197
    v_cvt_pk_bf16_f32 v197, v198, v199
    ds_write_b64 v251, v[196:197] offset:2048
    v_cvt_pk_bf16_f32 v200, v200, v201
    v_cvt_pk_bf16_f32 v201, v202, v203
    ds_write_b64 v251, v[200:201] offset:4096
    v_cvt_pk_bf16_f32 v204, v204, v205
    v_cvt_pk_bf16_f32 v205, v206, v207
    ds_write_b64 v251, v[204:205] offset:6144
    s_waitcnt lgkmcnt(0)
    s_barrier
    ds_read_b128 v[0:3], v254 offset:0
    ds_read_b128 v[4:7], v254 offset:1024
    s_add_u32 s49, s53, 256
    s_waitcnt lgkmcnt(1)
    buffer_store_dwordx4 v[0:3], v255, s[24:27], s49 offen sc0 sc1 nt
    s_add_u32 s49, s53, 7424
    s_waitcnt lgkmcnt(0)
    buffer_store_dwordx4 v[4:7], v255, s[24:27], s49 offen sc0 sc1 nt
    s_endpgm
L_helper:
    s_getpc_b64 s[56:57]
L_pc:
    s_sub_u32 s56, s56, L_pc-standalone__layernorm_linear__sampling_kernel
    s_subb_u32 s57, s57, 0
    s_mov_b32 s20, s10
    s_and_b32 s21, s11, 0xffff
    s_mov_b32 s22, 401408
    s_mov_b32 s23, 0x20000
    s_mov_b32 s24, s12
    s_and_b32 s25, s13, 0xffff
    s_mov_b32 s26, 14680064
    s_mov_b32 s27, 0x20000
    s_bitcmp1_b32 s2, 7
    s_cselect_b32 s39, 512, 0
    s_cselect_b32 s40, 64, 0
    s_add_u32 s40, s40, 384
    s_mul_i32 s50, s37, 7168
    s_add_u32 s50, s50, s39
    s_mul_i32 s51, s37, 14336
    s_add_u32 s51, s51, s40
    s_lshl_b32 s52, s37, 10
    s_mov_b32 s45, 0x00003f80
    s_mov_b32 s46, 0x3f800000
    s_mov_b32 s47, 0xffff0000
    s_add_u32 s53, s38, s39
    s_add_u32 s54, s38, s40
    s_lshl_b32 s43, s37, 12
    s_add_u32 s43, s43, 49152
    v_lshlrev_b32 v246, 6, v112
    v_bfe_u32 v113, v112, 4, 2
    v_bfe_u32 v114, v112, 0, 3
    v_xor_b32 v113, v113, v114
    s_lshl_b32 s49, s36, 2
    s_and_b32 s49, s49, 4
    v_xor_b32 v113, s49, v113
    v_lshlrev_b32 v241, 4, v113
    v_bfe_u32 v113, v112, 3, 3
    v_lshl_add_u32 v241, v113, 7, v241
    s_lshl_b32 s49, s36, 10
    s_add_u32 s49, s49, 49152
    v_add_u32 v241, s49, v241
    s_add_u32 s49, s49, 8192
    v_lshl_add_u32 v242, v114, 4, s49
    v_add_u32 v115, s49, v115
    v_bfe_u32 v113, v112, 2, 4
    v_bfe_u32 v114, v112, 0, 2
    v_mul_u32_u24 v253, 896, v113
    v_lshl_add_u32 v255, v114, 4, v253
    v_bfe_u32 v117, v112, 3, 2
    v_xor_b32 v117, v117, v114
    v_lshlrev_b32 v117, 4, v117
    s_lshl_b32 s49, s37, 11
    s_add_u32 s49, s49, 114688
    v_lshl_add_u32 v254, v113, 6, v117
    v_add_u32 v254, s49, v254
    v_bfe_u32 v113, v112, 1, 2
    v_bfe_u32 v114, v112, 4, 1
    v_xor_b32 v113, v113, v114
    s_and_b32 s49, s37, 1
    s_lshl_b32 s49, s49, 1
    v_xor_b32 v113, s49, v113
    v_lshl_add_u32 v243, v113, 5, v116
    v_bfe_u32 v113, v112, 0, 1
    v_lshl_add_u32 v243, v113, 4, v243
    s_add_u32 s48, s43, 81920
    v_bfe_u32 v113, v112, 3, 3
    v_bfe_u32 v114, v112, 0, 3
    v_xor_b32 v114, v114, v113
    v_lshlrev_b32 v114, 4, v114
    v_lshl_add_u32 v245, v113, 7, v114
    v_add_u32 v245, s48, v245
    v_bfe_u32 v113, v112, 1, 1
    v_bfe_u32 v114, v112, 5, 1
    v_xor_b32 v113, v113, v114
    v_lshl_add_u32 v253, v113, 5, v253
    v_bfe_u32 v113, v112, 0, 1
    v_lshl_add_u32 v253, v113, 4, v253
    s_mul_i32 s48, s37, 6144
    v_mul_u32_u24 v248, 96, v112
    v_add_u32 v248, s48, v248
    v_min_u32 v248, L_pad-standalone__layernorm_linear__sampling_kernel-4, v248
    v_mov_b32 v249, s57
    v_add_co_u32 v248, vcc, s56, v248
    s_nop 1
    v_addc_co_u32 v249, vcc, 0, v249, vcc
    s_waitcnt vmcnt(4)
    v_lshlrev_b32 v0, 16, v224
    v_and_b32 v1, s47, v224
    v_lshlrev_b32 v2, 16, v225
    v_and_b32 v3, s47, v225
    v_lshlrev_b32 v4, 16, v226
    v_and_b32 v5, s47, v226
    v_lshlrev_b32 v6, 16, v227
    v_and_b32 v7, s47, v227
    v_lshlrev_b32 v8, 16, v228
    v_and_b32 v9, s47, v228
    v_lshlrev_b32 v10, 16, v229
    v_and_b32 v11, s47, v229
    v_lshlrev_b32 v12, 16, v230
    v_and_b32 v13, s47, v230
    v_lshlrev_b32 v14, 16, v231
    v_and_b32 v15, s47, v231
    ds_write_b128 v115, v[0:3] offset:0
    ds_write_b128 v115, v[4:7] offset:16384
    ds_write_b128 v115, v[8:11] offset:32768
    ds_write_b128 v115, v[12:15] offset:49152
    v_lshlrev_b32 v236, 16, v168
    s_nop 1
    v_mov_b32_dpp v238, v236 quad_perm:[0,0,0,0] row_mask:0xf bank_mask:0xf
    s_nop 1
    v_mov_b32_dpp v238, v238 row_shr:4 row_mask:0xf bank_mask:0xa
    global_load_dwordx4 v[196:199], v240, s[16:17] offset:0 nt
    v_dot2_f32_bf16 v112, v168, s45, v238 neg_lo:[0,0,1]
    v_dot2_f32_bf16 v113, v168, s46, v238 neg_lo:[0,0,1]
    v_dot2_f32_bf16 v114, v169, s45, v238 neg_lo:[0,0,1]
    v_dot2_f32_bf16 v115, v169, s46, v238 neg_lo:[0,0,1]
    v_dot2_f32_bf16 v116, v170, s45, v238 neg_lo:[0,0,1]
    v_dot2_f32_bf16 v117, v170, s46, v238 neg_lo:[0,0,1]
    v_dot2_f32_bf16 v118, v171, s45, v238 neg_lo:[0,0,1]
    v_dot2_f32_bf16 v119, v171, s46, v238 neg_lo:[0,0,1]
    v_pk_add_f32 v[232:233], v[112:113], v[114:115]
    v_pk_mul_f32 v[234:235], v[112:113], v[112:113]
    v_pk_fma_f32 v[234:235], v[114:115], v[114:115], v[234:235]
    v_pk_add_f32 v[232:233], v[232:233], v[116:117]
    v_pk_fma_f32 v[234:235], v[116:117], v[116:117], v[234:235]
    v_pk_add_f32 v[232:233], v[232:233], v[118:119]
    v_pk_fma_f32 v[234:235], v[118:119], v[118:119], v[234:235]
    ds_read_b128 v[0:3], v242 offset:0
    ds_read_b128 v[4:7], v242 offset:16384
    ds_read_b128 v[8:11], v242 offset:32768
    ds_read_b128 v[12:15], v242 offset:49152
    global_load_dwordx4 v[200:203], v240, s[16:17] offset:128 nt
    v_dot2_f32_bf16 v120, v172, s45, v238 neg_lo:[0,0,1]
    v_dot2_f32_bf16 v121, v172, s46, v238 neg_lo:[0,0,1]
    v_dot2_f32_bf16 v122, v173, s45, v238 neg_lo:[0,0,1]
    v_dot2_f32_bf16 v123, v173, s46, v238 neg_lo:[0,0,1]
    v_dot2_f32_bf16 v124, v174, s45, v238 neg_lo:[0,0,1]
    v_dot2_f32_bf16 v125, v174, s46, v238 neg_lo:[0,0,1]
    v_dot2_f32_bf16 v126, v175, s45, v238 neg_lo:[0,0,1]
    v_dot2_f32_bf16 v127, v175, s46, v238 neg_lo:[0,0,1]
    v_pk_add_f32 v[232:233], v[232:233], v[120:121]
    v_pk_fma_f32 v[234:235], v[120:121], v[120:121], v[234:235]
    v_pk_add_f32 v[232:233], v[232:233], v[122:123]
    v_pk_fma_f32 v[234:235], v[122:123], v[122:123], v[234:235]
    v_pk_add_f32 v[232:233], v[232:233], v[124:125]
    v_pk_fma_f32 v[234:235], v[124:125], v[124:125], v[234:235]
    v_pk_add_f32 v[232:233], v[232:233], v[126:127]
    v_pk_fma_f32 v[234:235], v[126:127], v[126:127], v[234:235]
    ds_read_b128 v[16:19], v242 offset:128
    ds_read_b128 v[20:23], v242 offset:16512
    ds_read_b128 v[24:27], v242 offset:32896
    ds_read_b128 v[28:31], v242 offset:49280
    global_load_dwordx4 v[204:207], v240, s[16:17] offset:256 nt
    v_dot2_f32_bf16 v128, v176, s45, v238 neg_lo:[0,0,1]
    v_dot2_f32_bf16 v129, v176, s46, v238 neg_lo:[0,0,1]
    v_dot2_f32_bf16 v130, v177, s45, v238 neg_lo:[0,0,1]
    v_dot2_f32_bf16 v131, v177, s46, v238 neg_lo:[0,0,1]
    v_dot2_f32_bf16 v132, v178, s45, v238 neg_lo:[0,0,1]
    v_dot2_f32_bf16 v133, v178, s46, v238 neg_lo:[0,0,1]
    v_dot2_f32_bf16 v134, v179, s45, v238 neg_lo:[0,0,1]
    v_dot2_f32_bf16 v135, v179, s46, v238 neg_lo:[0,0,1]
    v_pk_add_f32 v[232:233], v[232:233], v[128:129]
    v_pk_fma_f32 v[234:235], v[128:129], v[128:129], v[234:235]
    v_pk_add_f32 v[232:233], v[232:233], v[130:131]
    v_pk_fma_f32 v[234:235], v[130:131], v[130:131], v[234:235]
    v_pk_add_f32 v[232:233], v[232:233], v[132:133]
    v_pk_fma_f32 v[234:235], v[132:133], v[132:133], v[234:235]
    v_pk_add_f32 v[232:233], v[232:233], v[134:135]
    v_pk_fma_f32 v[234:235], v[134:135], v[134:135], v[234:235]
    ds_read_b128 v[32:35], v242 offset:256
    ds_read_b128 v[36:39], v242 offset:16640
    ds_read_b128 v[40:43], v242 offset:33024
    ds_read_b128 v[44:47], v242 offset:49408
    s_waitcnt vmcnt(6)
    global_load_dwordx4 v[208:211], v240, s[16:17] offset:384 nt
    s_setprio 1
    v_dot2_f32_bf16 v136, v180, s45, v238 neg_lo:[0,0,1]
    v_dot2_f32_bf16 v137, v180, s46, v238 neg_lo:[0,0,1]
    v_dot2_f32_bf16 v138, v181, s45, v238 neg_lo:[0,0,1]
    v_dot2_f32_bf16 v139, v181, s46, v238 neg_lo:[0,0,1]
    v_dot2_f32_bf16 v140, v182, s45, v238 neg_lo:[0,0,1]
    v_dot2_f32_bf16 v141, v182, s46, v238 neg_lo:[0,0,1]
    v_dot2_f32_bf16 v142, v183, s45, v238 neg_lo:[0,0,1]
    v_dot2_f32_bf16 v143, v183, s46, v238 neg_lo:[0,0,1]
    v_pk_add_f32 v[232:233], v[232:233], v[136:137]
    v_pk_fma_f32 v[234:235], v[136:137], v[136:137], v[234:235]
    v_pk_add_f32 v[232:233], v[232:233], v[138:139]
    v_pk_fma_f32 v[234:235], v[138:139], v[138:139], v[234:235]
    v_pk_add_f32 v[232:233], v[232:233], v[140:141]
    v_pk_fma_f32 v[234:235], v[140:141], v[140:141], v[234:235]
    v_pk_add_f32 v[232:233], v[232:233], v[142:143]
    v_pk_fma_f32 v[234:235], v[142:143], v[142:143], v[234:235]
    ds_read_b128 v[48:51], v242 offset:384
    ds_read_b128 v[52:55], v242 offset:16768
    ds_read_b128 v[56:59], v242 offset:33152
    ds_read_b128 v[60:63], v242 offset:49536
    s_waitcnt vmcnt(6)
    global_load_dwordx4 v[212:215], v240, s[16:17] offset:512 nt
    v_dot2_f32_bf16 v144, v184, s45, v238 neg_lo:[0,0,1]
    v_dot2_f32_bf16 v145, v184, s46, v238 neg_lo:[0,0,1]
    v_dot2_f32_bf16 v146, v185, s45, v238 neg_lo:[0,0,1]
    v_dot2_f32_bf16 v147, v185, s46, v238 neg_lo:[0,0,1]
    v_dot2_f32_bf16 v148, v186, s45, v238 neg_lo:[0,0,1]
    v_dot2_f32_bf16 v149, v186, s46, v238 neg_lo:[0,0,1]
    v_dot2_f32_bf16 v150, v187, s45, v238 neg_lo:[0,0,1]
    v_dot2_f32_bf16 v151, v187, s46, v238 neg_lo:[0,0,1]
    v_pk_add_f32 v[232:233], v[232:233], v[144:145]
    v_pk_fma_f32 v[234:235], v[144:145], v[144:145], v[234:235]
    v_pk_add_f32 v[232:233], v[232:233], v[146:147]
    v_pk_fma_f32 v[234:235], v[146:147], v[146:147], v[234:235]
    v_pk_add_f32 v[232:233], v[232:233], v[148:149]
    v_pk_fma_f32 v[234:235], v[148:149], v[148:149], v[234:235]
    v_pk_add_f32 v[232:233], v[232:233], v[150:151]
    v_pk_fma_f32 v[234:235], v[150:151], v[150:151], v[234:235]
    ds_read_b128 v[64:67], v242 offset:512
    ds_read_b128 v[68:71], v242 offset:16896
    ds_read_b128 v[72:75], v242 offset:33280
    ds_read_b128 v[76:79], v242 offset:49664
    s_waitcnt vmcnt(6)
    global_load_dwordx4 v[216:219], v240, s[16:17] offset:640 nt
    v_dot2_f32_bf16 v152, v188, s45, v238 neg_lo:[0,0,1]
    v_dot2_f32_bf16 v153, v188, s46, v238 neg_lo:[0,0,1]
    v_dot2_f32_bf16 v154, v189, s45, v238 neg_lo:[0,0,1]
    v_dot2_f32_bf16 v155, v189, s46, v238 neg_lo:[0,0,1]
    v_dot2_f32_bf16 v156, v190, s45, v238 neg_lo:[0,0,1]
    v_dot2_f32_bf16 v157, v190, s46, v238 neg_lo:[0,0,1]
    v_dot2_f32_bf16 v158, v191, s45, v238 neg_lo:[0,0,1]
    v_dot2_f32_bf16 v159, v191, s46, v238 neg_lo:[0,0,1]
    v_pk_add_f32 v[232:233], v[232:233], v[152:153]
    v_pk_fma_f32 v[234:235], v[152:153], v[152:153], v[234:235]
    v_pk_add_f32 v[232:233], v[232:233], v[154:155]
    v_pk_fma_f32 v[234:235], v[154:155], v[154:155], v[234:235]
    v_pk_add_f32 v[232:233], v[232:233], v[156:157]
    v_pk_fma_f32 v[234:235], v[156:157], v[156:157], v[234:235]
    v_pk_add_f32 v[232:233], v[232:233], v[158:159]
    v_pk_fma_f32 v[234:235], v[158:159], v[158:159], v[234:235]
    ds_read_b128 v[80:83], v242 offset:640
    ds_read_b128 v[84:87], v242 offset:17024
    ds_read_b128 v[88:91], v242 offset:33408
    ds_read_b128 v[92:95], v242 offset:49792
    s_waitcnt vmcnt(6)
    global_load_dwordx4 v[220:223], v240, s[16:17] offset:768 nt
    v_dot2_f32_bf16 v160, v192, s45, v238 neg_lo:[0,0,1]
    v_dot2_f32_bf16 v161, v192, s46, v238 neg_lo:[0,0,1]
    v_dot2_f32_bf16 v162, v193, s45, v238 neg_lo:[0,0,1]
    v_dot2_f32_bf16 v163, v193, s46, v238 neg_lo:[0,0,1]
    v_dot2_f32_bf16 v164, v194, s45, v238 neg_lo:[0,0,1]
    v_dot2_f32_bf16 v165, v194, s46, v238 neg_lo:[0,0,1]
    v_dot2_f32_bf16 v166, v195, s45, v238 neg_lo:[0,0,1]
    v_dot2_f32_bf16 v167, v195, s46, v238 neg_lo:[0,0,1]
    v_pk_add_f32 v[232:233], v[232:233], v[160:161]
    v_pk_fma_f32 v[234:235], v[160:161], v[160:161], v[234:235]
    v_pk_add_f32 v[232:233], v[232:233], v[162:163]
    v_pk_fma_f32 v[234:235], v[162:163], v[162:163], v[234:235]
    v_pk_add_f32 v[232:233], v[232:233], v[164:165]
    v_pk_fma_f32 v[234:235], v[164:165], v[164:165], v[234:235]
    v_pk_add_f32 v[232:233], v[232:233], v[166:167]
    v_pk_fma_f32 v[234:235], v[166:167], v[166:167], v[234:235]
    ds_read_b128 v[96:99], v242 offset:768
    ds_read_b128 v[100:103], v242 offset:17152
    ds_read_b128 v[104:107], v242 offset:33536
    ds_read_b128 v[108:111], v242 offset:49920
    v_add_f32 v232, v232, v233
    v_add_f32 v234, v234, v235
    v_add_u32 v242, 0x10000, v241
    v_add_f32_dpp v232, v232, v232 quad_perm:[1,0,3,2] row_mask:0xf bank_mask:0xf
    v_add_f32_dpp v234, v234, v234 quad_perm:[1,0,3,2] row_mask:0xf bank_mask:0xf
    s_nop 0
    v_add_f32_dpp v232, v232, v232 quad_perm:[2,3,0,1] row_mask:0xf bank_mask:0xf
    v_add_f32_dpp v234, v234, v234 quad_perm:[2,3,0,1] row_mask:0xf bank_mask:0xf
    s_nop 0
    v_add_f32_dpp v232, v232, v232 row_half_mirror row_mask:0xf bank_mask:0xf
    v_add_f32_dpp v234, v234, v234 row_half_mirror row_mask:0xf bank_mask:0xf
    v_mul_f32 v232, 0x3b124925, v232
    v_mul_f32 v234, 0x3b124925, v234
    v_fma_f32 v234, -v232, v232, v234
    v_add_f32 v232, v232, v238
    v_cvt_pk_bf16_f32 v234, 0, v234
    v_cvt_pk_bf16_f32 v232, 0, v232
    v_add_f32 v234, 0x3727c5ac, v234
    v_cvt_pk_bf16_f32 v234, 0, v234
    v_sqrt_f32 v234, v234
    v_sub_f32 v232, v238, v232
    v_cvt_pk_bf16_f32 v234, 0, v234
    v_rcp_f32 v236, v234
    s_nop 0
    v_mul_f32 v237, v232, v236
    v_pk_fma_f32 v[112:113], v[112:113], v[236:237], v[236:237] op_sel:[0,0,1] op_sel_hi:[1,0,1]
    v_pk_fma_f32 v[114:115], v[114:115], v[236:237], v[236:237] op_sel:[0,0,1] op_sel_hi:[1,0,1]
    v_pk_fma_f32 v[116:117], v[116:117], v[236:237], v[236:237] op_sel:[0,0,1] op_sel_hi:[1,0,1]
    v_pk_fma_f32 v[118:119], v[118:119], v[236:237], v[236:237] op_sel:[0,0,1] op_sel_hi:[1,0,1]
    s_waitcnt lgkmcnt(15)
    v_pk_fma_f32 v[112:113], v[112:113], v[0:1], v[8:9]
    v_pk_fma_f32 v[114:115], v[114:115], v[2:3], v[10:11]
    v_pk_fma_f32 v[116:117], v[116:117], v[4:5], v[12:13]
    v_pk_fma_f32 v[118:119], v[118:119], v[6:7], v[14:15]
    v_cvt_pk_bf16_f32 v224, v112, v113
    v_cvt_pk_bf16_f32 v225, v114, v115
    v_cvt_pk_bf16_f32 v226, v116, v117
    v_cvt_pk_bf16_f32 v227, v118, v119
    v_pk_fma_f32 v[120:121], v[120:121], v[236:237], v[236:237] op_sel:[0,0,1] op_sel_hi:[1,0,1]
    v_pk_fma_f32 v[122:123], v[122:123], v[236:237], v[236:237] op_sel:[0,0,1] op_sel_hi:[1,0,1]
    v_pk_fma_f32 v[124:125], v[124:125], v[236:237], v[236:237] op_sel:[0,0,1] op_sel_hi:[1,0,1]
    v_pk_fma_f32 v[126:127], v[126:127], v[236:237], v[236:237] op_sel:[0,0,1] op_sel_hi:[1,0,1]
    ds_write_b128 v241, v[224:227] offset:0
    s_waitcnt lgkmcnt(15)
    v_pk_fma_f32 v[120:121], v[120:121], v[16:17], v[24:25]
    v_pk_fma_f32 v[122:123], v[122:123], v[18:19], v[26:27]
    v_pk_fma_f32 v[124:125], v[124:125], v[20:21], v[28:29]
    v_pk_fma_f32 v[126:127], v[126:127], v[22:23], v[30:31]
    v_cvt_pk_bf16_f32 v228, v120, v121
    v_cvt_pk_bf16_f32 v229, v122, v123
    v_cvt_pk_bf16_f32 v230, v124, v125
    v_cvt_pk_bf16_f32 v231, v126, v127
    v_pk_fma_f32 v[128:129], v[128:129], v[236:237], v[236:237] op_sel:[0,0,1] op_sel_hi:[1,0,1]
    v_pk_fma_f32 v[130:131], v[130:131], v[236:237], v[236:237] op_sel:[0,0,1] op_sel_hi:[1,0,1]
    v_pk_fma_f32 v[132:133], v[132:133], v[236:237], v[236:237] op_sel:[0,0,1] op_sel_hi:[1,0,1]
    v_pk_fma_f32 v[134:135], v[134:135], v[236:237], v[236:237] op_sel:[0,0,1] op_sel_hi:[1,0,1]
    ds_write_b128 v241, v[228:231] offset:16384
    s_waitcnt lgkmcnt(15)
    v_pk_fma_f32 v[128:129], v[128:129], v[32:33], v[40:41]
    v_pk_fma_f32 v[130:131], v[130:131], v[34:35], v[42:43]
    v_pk_fma_f32 v[132:133], v[132:133], v[36:37], v[44:45]
    v_pk_fma_f32 v[134:135], v[134:135], v[38:39], v[46:47]
    v_cvt_pk_bf16_f32 v224, v128, v129
    v_cvt_pk_bf16_f32 v225, v130, v131
    v_cvt_pk_bf16_f32 v226, v132, v133
    v_cvt_pk_bf16_f32 v227, v134, v135
    v_pk_fma_f32 v[136:137], v[136:137], v[236:237], v[236:237] op_sel:[0,0,1] op_sel_hi:[1,0,1]
    v_pk_fma_f32 v[138:139], v[138:139], v[236:237], v[236:237] op_sel:[0,0,1] op_sel_hi:[1,0,1]
    v_pk_fma_f32 v[140:141], v[140:141], v[236:237], v[236:237] op_sel:[0,0,1] op_sel_hi:[1,0,1]
    v_pk_fma_f32 v[142:143], v[142:143], v[236:237], v[236:237] op_sel:[0,0,1] op_sel_hi:[1,0,1]
    ds_write_b128 v241, v[224:227] offset:32768
    s_waitcnt lgkmcnt(15)
    v_pk_fma_f32 v[136:137], v[136:137], v[48:49], v[56:57]
    v_pk_fma_f32 v[138:139], v[138:139], v[50:51], v[58:59]
    v_pk_fma_f32 v[140:141], v[140:141], v[52:53], v[60:61]
    v_pk_fma_f32 v[142:143], v[142:143], v[54:55], v[62:63]
    v_cvt_pk_bf16_f32 v228, v136, v137
    v_cvt_pk_bf16_f32 v229, v138, v139
    v_cvt_pk_bf16_f32 v230, v140, v141
    v_cvt_pk_bf16_f32 v231, v142, v143
    v_pk_fma_f32 v[144:145], v[144:145], v[236:237], v[236:237] op_sel:[0,0,1] op_sel_hi:[1,0,1]
    v_pk_fma_f32 v[146:147], v[146:147], v[236:237], v[236:237] op_sel:[0,0,1] op_sel_hi:[1,0,1]
    v_pk_fma_f32 v[148:149], v[148:149], v[236:237], v[236:237] op_sel:[0,0,1] op_sel_hi:[1,0,1]
    v_pk_fma_f32 v[150:151], v[150:151], v[236:237], v[236:237] op_sel:[0,0,1] op_sel_hi:[1,0,1]
    ds_write_b128 v241, v[228:231] offset:49152
    s_waitcnt lgkmcnt(12)
    v_pk_fma_f32 v[144:145], v[144:145], v[64:65], v[72:73]
    v_pk_fma_f32 v[146:147], v[146:147], v[66:67], v[74:75]
    v_pk_fma_f32 v[148:149], v[148:149], v[68:69], v[76:77]
    v_pk_fma_f32 v[150:151], v[150:151], v[70:71], v[78:79]
    v_cvt_pk_bf16_f32 v224, v144, v145
    v_cvt_pk_bf16_f32 v225, v146, v147
    v_cvt_pk_bf16_f32 v226, v148, v149
    v_cvt_pk_bf16_f32 v227, v150, v151
    v_pk_fma_f32 v[152:153], v[152:153], v[236:237], v[236:237] op_sel:[0,0,1] op_sel_hi:[1,0,1]
    v_pk_fma_f32 v[154:155], v[154:155], v[236:237], v[236:237] op_sel:[0,0,1] op_sel_hi:[1,0,1]
    v_pk_fma_f32 v[156:157], v[156:157], v[236:237], v[236:237] op_sel:[0,0,1] op_sel_hi:[1,0,1]
    v_pk_fma_f32 v[158:159], v[158:159], v[236:237], v[236:237] op_sel:[0,0,1] op_sel_hi:[1,0,1]
    ds_write_b128 v242, v[224:227] offset:0
    s_waitcnt lgkmcnt(9)
    v_pk_fma_f32 v[152:153], v[152:153], v[80:81], v[88:89]
    v_pk_fma_f32 v[154:155], v[154:155], v[82:83], v[90:91]
    v_pk_fma_f32 v[156:157], v[156:157], v[84:85], v[92:93]
    v_pk_fma_f32 v[158:159], v[158:159], v[86:87], v[94:95]
    v_cvt_pk_bf16_f32 v228, v152, v153
    v_cvt_pk_bf16_f32 v229, v154, v155
    v_cvt_pk_bf16_f32 v230, v156, v157
    v_cvt_pk_bf16_f32 v231, v158, v159
    v_pk_fma_f32 v[160:161], v[160:161], v[236:237], v[236:237] op_sel:[0,0,1] op_sel_hi:[1,0,1]
    v_pk_fma_f32 v[162:163], v[162:163], v[236:237], v[236:237] op_sel:[0,0,1] op_sel_hi:[1,0,1]
    v_pk_fma_f32 v[164:165], v[164:165], v[236:237], v[236:237] op_sel:[0,0,1] op_sel_hi:[1,0,1]
    v_pk_fma_f32 v[166:167], v[166:167], v[236:237], v[236:237] op_sel:[0,0,1] op_sel_hi:[1,0,1]
    ds_write_b128 v242, v[228:231] offset:16384
    s_waitcnt lgkmcnt(6)
    v_pk_fma_f32 v[160:161], v[160:161], v[96:97], v[104:105]
    v_pk_fma_f32 v[162:163], v[162:163], v[98:99], v[106:107]
    v_pk_fma_f32 v[164:165], v[164:165], v[100:101], v[108:109]
    v_pk_fma_f32 v[166:167], v[166:167], v[102:103], v[110:111]
    v_cvt_pk_bf16_f32 v224, v160, v161
    v_cvt_pk_bf16_f32 v225, v162, v163
    v_cvt_pk_bf16_f32 v226, v164, v165
    v_cvt_pk_bf16_f32 v227, v166, v167
    ds_write_b128 v242, v[224:227] offset:32768
    s_waitcnt vmcnt(6)
    v_lshlrev_b32 v236, 16, v196
    s_nop 1
    v_mov_b32_dpp v238, v236 quad_perm:[0,0,0,0] row_mask:0xf bank_mask:0xf
    s_nop 1
    v_mov_b32_dpp v238, v238 row_shr:4 row_mask:0xf bank_mask:0xa
    v_dot2_f32_bf16 v112, v196, s45, v238 neg_lo:[0,0,1]
    v_dot2_f32_bf16 v113, v196, s46, v238 neg_lo:[0,0,1]
    v_dot2_f32_bf16 v114, v197, s45, v238 neg_lo:[0,0,1]
    v_dot2_f32_bf16 v115, v197, s46, v238 neg_lo:[0,0,1]
    v_dot2_f32_bf16 v116, v198, s45, v238 neg_lo:[0,0,1]
    v_dot2_f32_bf16 v117, v198, s46, v238 neg_lo:[0,0,1]
    v_dot2_f32_bf16 v118, v199, s45, v238 neg_lo:[0,0,1]
    v_dot2_f32_bf16 v119, v199, s46, v238 neg_lo:[0,0,1]
    v_pk_add_f32 v[232:233], v[112:113], v[114:115]
    v_pk_mul_f32 v[234:235], v[112:113], v[112:113]
    v_pk_fma_f32 v[234:235], v[114:115], v[114:115], v[234:235]
    v_pk_add_f32 v[232:233], v[232:233], v[116:117]
    v_pk_fma_f32 v[234:235], v[116:117], v[116:117], v[234:235]
    v_pk_add_f32 v[232:233], v[232:233], v[118:119]
    v_pk_fma_f32 v[234:235], v[118:119], v[118:119], v[234:235]
    s_waitcnt vmcnt(5)
    v_dot2_f32_bf16 v120, v200, s45, v238 neg_lo:[0,0,1]
    v_dot2_f32_bf16 v121, v200, s46, v238 neg_lo:[0,0,1]
    v_dot2_f32_bf16 v122, v201, s45, v238 neg_lo:[0,0,1]
    v_dot2_f32_bf16 v123, v201, s46, v238 neg_lo:[0,0,1]
    v_dot2_f32_bf16 v124, v202, s45, v238 neg_lo:[0,0,1]
    v_dot2_f32_bf16 v125, v202, s46, v238 neg_lo:[0,0,1]
    v_dot2_f32_bf16 v126, v203, s45, v238 neg_lo:[0,0,1]
    v_dot2_f32_bf16 v127, v203, s46, v238 neg_lo:[0,0,1]
    v_pk_add_f32 v[232:233], v[232:233], v[120:121]
    v_pk_fma_f32 v[234:235], v[120:121], v[120:121], v[234:235]
    v_pk_add_f32 v[232:233], v[232:233], v[122:123]
    v_pk_fma_f32 v[234:235], v[122:123], v[122:123], v[234:235]
    v_pk_add_f32 v[232:233], v[232:233], v[124:125]
    v_pk_fma_f32 v[234:235], v[124:125], v[124:125], v[234:235]
    v_pk_add_f32 v[232:233], v[232:233], v[126:127]
    v_pk_fma_f32 v[234:235], v[126:127], v[126:127], v[234:235]
    s_waitcnt vmcnt(4)
    v_dot2_f32_bf16 v128, v204, s45, v238 neg_lo:[0,0,1]
    v_dot2_f32_bf16 v129, v204, s46, v238 neg_lo:[0,0,1]
    v_dot2_f32_bf16 v130, v205, s45, v238 neg_lo:[0,0,1]
    v_dot2_f32_bf16 v131, v205, s46, v238 neg_lo:[0,0,1]
    v_dot2_f32_bf16 v132, v206, s45, v238 neg_lo:[0,0,1]
    v_dot2_f32_bf16 v133, v206, s46, v238 neg_lo:[0,0,1]
    v_dot2_f32_bf16 v134, v207, s45, v238 neg_lo:[0,0,1]
    v_dot2_f32_bf16 v135, v207, s46, v238 neg_lo:[0,0,1]
    v_pk_add_f32 v[232:233], v[232:233], v[128:129]
    v_pk_fma_f32 v[234:235], v[128:129], v[128:129], v[234:235]
    v_pk_add_f32 v[232:233], v[232:233], v[130:131]
    v_pk_fma_f32 v[234:235], v[130:131], v[130:131], v[234:235]
    v_pk_add_f32 v[232:233], v[232:233], v[132:133]
    v_pk_fma_f32 v[234:235], v[132:133], v[132:133], v[234:235]
    v_pk_add_f32 v[232:233], v[232:233], v[134:135]
    v_pk_fma_f32 v[234:235], v[134:135], v[134:135], v[234:235]
    s_waitcnt vmcnt(3)
    s_add_u32 m0, s52, 4096
    s_add_u32 s48, s50, 28672
    buffer_load_dwordx4 v243, s[20:23], s48 offen  lds
    v_dot2_f32_bf16 v136, v208, s45, v238 neg_lo:[0,0,1]
    v_dot2_f32_bf16 v137, v208, s46, v238 neg_lo:[0,0,1]
    v_dot2_f32_bf16 v138, v209, s45, v238 neg_lo:[0,0,1]
    v_dot2_f32_bf16 v139, v209, s46, v238 neg_lo:[0,0,1]
    v_dot2_f32_bf16 v140, v210, s45, v238 neg_lo:[0,0,1]
    v_dot2_f32_bf16 v141, v210, s46, v238 neg_lo:[0,0,1]
    v_dot2_f32_bf16 v142, v211, s45, v238 neg_lo:[0,0,1]
    v_dot2_f32_bf16 v143, v211, s46, v238 neg_lo:[0,0,1]
    v_pk_add_f32 v[232:233], v[232:233], v[136:137]
    v_pk_fma_f32 v[234:235], v[136:137], v[136:137], v[234:235]
    v_pk_add_f32 v[232:233], v[232:233], v[138:139]
    v_pk_fma_f32 v[234:235], v[138:139], v[138:139], v[234:235]
    v_pk_add_f32 v[232:233], v[232:233], v[140:141]
    v_pk_fma_f32 v[234:235], v[140:141], v[140:141], v[234:235]
    v_pk_add_f32 v[232:233], v[232:233], v[142:143]
    v_pk_fma_f32 v[234:235], v[142:143], v[142:143], v[234:235]
    s_waitcnt vmcnt(3)
    s_add_u32 m0, s52, 12288
    s_add_u32 s48, s50, 86016
    buffer_load_dwordx4 v243, s[20:23], s48 offen  lds
    v_dot2_f32_bf16 v144, v212, s45, v238 neg_lo:[0,0,1]
    v_dot2_f32_bf16 v145, v212, s46, v238 neg_lo:[0,0,1]
    v_dot2_f32_bf16 v146, v213, s45, v238 neg_lo:[0,0,1]
    v_dot2_f32_bf16 v147, v213, s46, v238 neg_lo:[0,0,1]
    v_dot2_f32_bf16 v148, v214, s45, v238 neg_lo:[0,0,1]
    v_dot2_f32_bf16 v149, v214, s46, v238 neg_lo:[0,0,1]
    v_dot2_f32_bf16 v150, v215, s45, v238 neg_lo:[0,0,1]
    v_dot2_f32_bf16 v151, v215, s46, v238 neg_lo:[0,0,1]
    v_pk_add_f32 v[232:233], v[232:233], v[144:145]
    v_pk_fma_f32 v[234:235], v[144:145], v[144:145], v[234:235]
    v_pk_add_f32 v[232:233], v[232:233], v[146:147]
    v_pk_fma_f32 v[234:235], v[146:147], v[146:147], v[234:235]
    v_pk_add_f32 v[232:233], v[232:233], v[148:149]
    v_pk_fma_f32 v[234:235], v[148:149], v[148:149], v[234:235]
    v_pk_add_f32 v[232:233], v[232:233], v[150:151]
    v_pk_fma_f32 v[234:235], v[150:151], v[150:151], v[234:235]
    s_waitcnt vmcnt(3)
    s_add_u32 m0, s52, 20480
    s_add_u32 s48, s50, 143360
    buffer_load_dwordx4 v243, s[20:23], s48 offen  lds
    v_dot2_f32_bf16 v152, v216, s45, v238 neg_lo:[0,0,1]
    v_dot2_f32_bf16 v153, v216, s46, v238 neg_lo:[0,0,1]
    v_dot2_f32_bf16 v154, v217, s45, v238 neg_lo:[0,0,1]
    v_dot2_f32_bf16 v155, v217, s46, v238 neg_lo:[0,0,1]
    v_dot2_f32_bf16 v156, v218, s45, v238 neg_lo:[0,0,1]
    v_dot2_f32_bf16 v157, v218, s46, v238 neg_lo:[0,0,1]
    v_dot2_f32_bf16 v158, v219, s45, v238 neg_lo:[0,0,1]
    v_dot2_f32_bf16 v159, v219, s46, v238 neg_lo:[0,0,1]
    v_pk_add_f32 v[232:233], v[232:233], v[152:153]
    v_pk_fma_f32 v[234:235], v[152:153], v[152:153], v[234:235]
    v_pk_add_f32 v[232:233], v[232:233], v[154:155]
    v_pk_fma_f32 v[234:235], v[154:155], v[154:155], v[234:235]
    v_pk_add_f32 v[232:233], v[232:233], v[156:157]
    v_pk_fma_f32 v[234:235], v[156:157], v[156:157], v[234:235]
    v_pk_add_f32 v[232:233], v[232:233], v[158:159]
    v_pk_fma_f32 v[234:235], v[158:159], v[158:159], v[234:235]
    s_waitcnt vmcnt(3)
    s_lshr_b32 s48, s2, 3
    s_mul_i32 s48, s48, 12544
    s_mul_i32 s49, s37, 3136
    s_add_u32 s48, s48, s49
    buffer_load_dword v246, v246, s[20:23], s48 offen
    global_load_dword v248, v[248:249], off
    v_dot2_f32_bf16 v160, v220, s45, v238 neg_lo:[0,0,1]
    v_dot2_f32_bf16 v161, v220, s46, v238 neg_lo:[0,0,1]
    v_dot2_f32_bf16 v162, v221, s45, v238 neg_lo:[0,0,1]
    v_dot2_f32_bf16 v163, v221, s46, v238 neg_lo:[0,0,1]
    v_dot2_f32_bf16 v164, v222, s45, v238 neg_lo:[0,0,1]
    v_dot2_f32_bf16 v165, v222, s46, v238 neg_lo:[0,0,1]
    v_dot2_f32_bf16 v166, v223, s45, v238 neg_lo:[0,0,1]
    v_dot2_f32_bf16 v167, v223, s46, v238 neg_lo:[0,0,1]
    v_pk_add_f32 v[232:233], v[232:233], v[160:161]
    v_pk_fma_f32 v[234:235], v[160:161], v[160:161], v[234:235]
    v_pk_add_f32 v[232:233], v[232:233], v[162:163]
    v_pk_fma_f32 v[234:235], v[162:163], v[162:163], v[234:235]
    v_pk_add_f32 v[232:233], v[232:233], v[164:165]
    v_pk_fma_f32 v[234:235], v[164:165], v[164:165], v[234:235]
    v_pk_add_f32 v[232:233], v[232:233], v[166:167]
    v_pk_fma_f32 v[234:235], v[166:167], v[166:167], v[234:235]
    v_add_f32 v232, v232, v233
    v_add_f32 v234, v234, v235
    v_subrev_u32 v240, s41, v240
    v_add_f32_dpp v232, v232, v232 quad_perm:[1,0,3,2] row_mask:0xf bank_mask:0xf
    v_add_f32_dpp v234, v234, v234 quad_perm:[1,0,3,2] row_mask:0xf bank_mask:0xf
    s_nop 0
    v_add_f32_dpp v232, v232, v232 quad_perm:[2,3,0,1] row_mask:0xf bank_mask:0xf
    v_add_f32_dpp v234, v234, v234 quad_perm:[2,3,0,1] row_mask:0xf bank_mask:0xf
    s_nop 0
    v_add_f32_dpp v232, v232, v232 row_half_mirror row_mask:0xf bank_mask:0xf
    v_add_f32_dpp v234, v234, v234 row_half_mirror row_mask:0xf bank_mask:0xf
    v_mul_f32 v232, 0x3b124925, v232
    v_mul_f32 v234, 0x3b124925, v234
    v_fma_f32 v234, -v232, v232, v234
    v_add_f32 v232, v232, v238
    v_cvt_pk_bf16_f32 v234, 0, v234
    v_cvt_pk_bf16_f32 v232, 0, v232
    v_add_f32 v234, 0x3727c5ac, v234
    v_cvt_pk_bf16_f32 v234, 0, v234
    v_sqrt_f32 v234, v234
    v_sub_f32 v232, v238, v232
    v_cvt_pk_bf16_f32 v234, 0, v234
    v_rcp_f32 v236, v234
    s_nop 0
    v_mul_f32 v237, v232, v236
    v_pk_fma_f32 v[112:113], v[112:113], v[236:237], v[236:237] op_sel:[0,0,1] op_sel_hi:[1,0,1]
    v_pk_fma_f32 v[114:115], v[114:115], v[236:237], v[236:237] op_sel:[0,0,1] op_sel_hi:[1,0,1]
    v_pk_fma_f32 v[116:117], v[116:117], v[236:237], v[236:237] op_sel:[0,0,1] op_sel_hi:[1,0,1]
    v_pk_fma_f32 v[118:119], v[118:119], v[236:237], v[236:237] op_sel:[0,0,1] op_sel_hi:[1,0,1]
    v_pk_fma_f32 v[112:113], v[112:113], v[0:1], v[8:9]
    v_pk_fma_f32 v[114:115], v[114:115], v[2:3], v[10:11]
    v_pk_fma_f32 v[116:117], v[116:117], v[4:5], v[12:13]
    v_pk_fma_f32 v[118:119], v[118:119], v[6:7], v[14:15]
    v_cvt_pk_bf16_f32 v224, v112, v113
    v_cvt_pk_bf16_f32 v225, v114, v115
    v_cvt_pk_bf16_f32 v226, v116, v117
    v_cvt_pk_bf16_f32 v227, v118, v119
    v_pk_fma_f32 v[120:121], v[120:121], v[236:237], v[236:237] op_sel:[0,0,1] op_sel_hi:[1,0,1]
    v_pk_fma_f32 v[122:123], v[122:123], v[236:237], v[236:237] op_sel:[0,0,1] op_sel_hi:[1,0,1]
    v_pk_fma_f32 v[124:125], v[124:125], v[236:237], v[236:237] op_sel:[0,0,1] op_sel_hi:[1,0,1]
    v_pk_fma_f32 v[126:127], v[126:127], v[236:237], v[236:237] op_sel:[0,0,1] op_sel_hi:[1,0,1]
    ds_write_b128 v241, v[224:227] offset:8192
    v_pk_fma_f32 v[120:121], v[120:121], v[16:17], v[24:25]
    v_pk_fma_f32 v[122:123], v[122:123], v[18:19], v[26:27]
    v_pk_fma_f32 v[124:125], v[124:125], v[20:21], v[28:29]
    v_pk_fma_f32 v[126:127], v[126:127], v[22:23], v[30:31]
    v_cvt_pk_bf16_f32 v228, v120, v121
    v_cvt_pk_bf16_f32 v229, v122, v123
    v_cvt_pk_bf16_f32 v230, v124, v125
    v_cvt_pk_bf16_f32 v231, v126, v127
    v_pk_fma_f32 v[128:129], v[128:129], v[236:237], v[236:237] op_sel:[0,0,1] op_sel_hi:[1,0,1]
    v_pk_fma_f32 v[130:131], v[130:131], v[236:237], v[236:237] op_sel:[0,0,1] op_sel_hi:[1,0,1]
    v_pk_fma_f32 v[132:133], v[132:133], v[236:237], v[236:237] op_sel:[0,0,1] op_sel_hi:[1,0,1]
    v_pk_fma_f32 v[134:135], v[134:135], v[236:237], v[236:237] op_sel:[0,0,1] op_sel_hi:[1,0,1]
    ds_write_b128 v241, v[228:231] offset:24576
    v_pk_fma_f32 v[128:129], v[128:129], v[32:33], v[40:41]
    v_pk_fma_f32 v[130:131], v[130:131], v[34:35], v[42:43]
    v_pk_fma_f32 v[132:133], v[132:133], v[36:37], v[44:45]
    v_pk_fma_f32 v[134:135], v[134:135], v[38:39], v[46:47]
    v_cvt_pk_bf16_f32 v224, v128, v129
    v_cvt_pk_bf16_f32 v225, v130, v131
    v_cvt_pk_bf16_f32 v226, v132, v133
    v_cvt_pk_bf16_f32 v227, v134, v135
    v_pk_fma_f32 v[136:137], v[136:137], v[236:237], v[236:237] op_sel:[0,0,1] op_sel_hi:[1,0,1]
    v_pk_fma_f32 v[138:139], v[138:139], v[236:237], v[236:237] op_sel:[0,0,1] op_sel_hi:[1,0,1]
    v_pk_fma_f32 v[140:141], v[140:141], v[236:237], v[236:237] op_sel:[0,0,1] op_sel_hi:[1,0,1]
    v_pk_fma_f32 v[142:143], v[142:143], v[236:237], v[236:237] op_sel:[0,0,1] op_sel_hi:[1,0,1]
    ds_write_b128 v241, v[224:227] offset:40960
    v_pk_fma_f32 v[136:137], v[136:137], v[48:49], v[56:57]
    v_pk_fma_f32 v[138:139], v[138:139], v[50:51], v[58:59]
    v_pk_fma_f32 v[140:141], v[140:141], v[52:53], v[60:61]
    v_pk_fma_f32 v[142:143], v[142:143], v[54:55], v[62:63]
    v_cvt_pk_bf16_f32 v228, v136, v137
    v_cvt_pk_bf16_f32 v229, v138, v139
    v_cvt_pk_bf16_f32 v230, v140, v141
    v_cvt_pk_bf16_f32 v231, v142, v143
    v_pk_fma_f32 v[144:145], v[144:145], v[236:237], v[236:237] op_sel:[0,0,1] op_sel_hi:[1,0,1]
    v_pk_fma_f32 v[146:147], v[146:147], v[236:237], v[236:237] op_sel:[0,0,1] op_sel_hi:[1,0,1]
    v_pk_fma_f32 v[148:149], v[148:149], v[236:237], v[236:237] op_sel:[0,0,1] op_sel_hi:[1,0,1]
    v_pk_fma_f32 v[150:151], v[150:151], v[236:237], v[236:237] op_sel:[0,0,1] op_sel_hi:[1,0,1]
    ds_write_b128 v241, v[228:231] offset:57344
    v_pk_fma_f32 v[144:145], v[144:145], v[64:65], v[72:73]
    v_pk_fma_f32 v[146:147], v[146:147], v[66:67], v[74:75]
    v_pk_fma_f32 v[148:149], v[148:149], v[68:69], v[76:77]
    v_pk_fma_f32 v[150:151], v[150:151], v[70:71], v[78:79]
    v_cvt_pk_bf16_f32 v224, v144, v145
    v_cvt_pk_bf16_f32 v225, v146, v147
    v_cvt_pk_bf16_f32 v226, v148, v149
    v_cvt_pk_bf16_f32 v227, v150, v151
    v_pk_fma_f32 v[152:153], v[152:153], v[236:237], v[236:237] op_sel:[0,0,1] op_sel_hi:[1,0,1]
    v_pk_fma_f32 v[154:155], v[154:155], v[236:237], v[236:237] op_sel:[0,0,1] op_sel_hi:[1,0,1]
    v_pk_fma_f32 v[156:157], v[156:157], v[236:237], v[236:237] op_sel:[0,0,1] op_sel_hi:[1,0,1]
    v_pk_fma_f32 v[158:159], v[158:159], v[236:237], v[236:237] op_sel:[0,0,1] op_sel_hi:[1,0,1]
    ds_write_b128 v242, v[224:227] offset:8192
    v_pk_fma_f32 v[152:153], v[152:153], v[80:81], v[88:89]
    v_pk_fma_f32 v[154:155], v[154:155], v[82:83], v[90:91]
    v_pk_fma_f32 v[156:157], v[156:157], v[84:85], v[92:93]
    v_pk_fma_f32 v[158:159], v[158:159], v[86:87], v[94:95]
    v_cvt_pk_bf16_f32 v228, v152, v153
    v_cvt_pk_bf16_f32 v229, v154, v155
    v_cvt_pk_bf16_f32 v230, v156, v157
    v_cvt_pk_bf16_f32 v231, v158, v159
    v_pk_fma_f32 v[160:161], v[160:161], v[236:237], v[236:237] op_sel:[0,0,1] op_sel_hi:[1,0,1]
    v_pk_fma_f32 v[162:163], v[162:163], v[236:237], v[236:237] op_sel:[0,0,1] op_sel_hi:[1,0,1]
    v_pk_fma_f32 v[164:165], v[164:165], v[236:237], v[236:237] op_sel:[0,0,1] op_sel_hi:[1,0,1]
    v_pk_fma_f32 v[166:167], v[166:167], v[236:237], v[236:237] op_sel:[0,0,1] op_sel_hi:[1,0,1]
    ds_write_b128 v242, v[228:231] offset:24576
    v_pk_fma_f32 v[160:161], v[160:161], v[96:97], v[104:105]
    v_pk_fma_f32 v[162:163], v[162:163], v[98:99], v[106:107]
    v_pk_fma_f32 v[164:165], v[164:165], v[100:101], v[108:109]
    v_pk_fma_f32 v[166:167], v[166:167], v[102:103], v[110:111]
    v_cvt_pk_bf16_f32 v224, v160, v161
    v_cvt_pk_bf16_f32 v225, v162, v163
    v_cvt_pk_bf16_f32 v226, v164, v165
    v_cvt_pk_bf16_f32 v227, v166, v167
    ds_write_b128 v242, v[224:227] offset:40960
    s_waitcnt vmcnt(4)
    s_waitcnt vmcnt(3)
    s_waitcnt lgkmcnt(0)
    s_barrier
    s_add_u32 m0, s52, 28672
    s_add_u32 s48, s51, 0
    buffer_load_dwordx4 v253, s[20:23], s48 offen  lds
    s_add_u32 m0, s52, 32768
    s_add_u32 s48, s51, 57344
    buffer_load_dwordx4 v253, s[20:23], s48 offen  lds
    s_add_u32 m0, s52, 36864
    s_add_u32 s48, s51, 114688
    buffer_load_dwordx4 v253, s[20:23], s48 offen  lds
    s_add_u32 m0, s52, 40960
    s_add_u32 s48, s51, 172032
    buffer_load_dwordx4 v253, s[20:23], s48 offen  lds
    s_waitcnt vmcnt(6)
    s_barrier
    s_add_u32 m0, s52, 49152
    s_add_u32 s48, s50, 128
    buffer_load_dwordx4 v243, s[20:23], s48 offen  lds
    s_add_u32 m0, s52, 53248
    s_add_u32 s48, s50, 28800
    buffer_load_dwordx4 v243, s[20:23], s48 offen  lds
    s_add_u32 m0, s52, 57344
    s_add_u32 s48, s50, 57472
    buffer_load_dwordx4 v243, s[20:23], s48 offen  lds
    s_add_u32 m0, s52, 61440
    s_add_u32 s48, s50, 86144
    buffer_load_dwordx4 v243, s[20:23], s48 offen  lds
    s_add_u32 m0, s52, 65536
    s_add_u32 s48, s50, 114816
    buffer_load_dwordx4 v243, s[20:23], s48 offen  lds
    s_add_u32 m0, s52, 69632
    s_add_u32 s48, s50, 143488
    buffer_load_dwordx4 v243, s[20:23], s48 offen  lds
    s_add_u32 m0, s52, 73728
    s_add_u32 s48, s50, 172160
    buffer_load_dwordx4 v243, s[20:23], s48 offen  lds
    s_waitcnt vmcnt(7)
    s_barrier
    s_waitcnt vmcnt(0)
    s_barrier
    s_add_u32 m0, s52, 77824
    s_add_u32 s48, s50, 256
    buffer_load_dwordx4 v243, s[20:23], s48 offen  lds
    s_add_u32 m0, s52, 81920
    s_add_u32 s48, s50, 28928
    buffer_load_dwordx4 v243, s[20:23], s48 offen  lds
    s_add_u32 m0, s52, 86016
    s_add_u32 s48, s50, 57600
    buffer_load_dwordx4 v243, s[20:23], s48 offen  lds
    s_add_u32 m0, s52, 90112
    s_add_u32 s48, s50, 86272
    buffer_load_dwordx4 v243, s[20:23], s48 offen  lds
    s_add_u32 m0, s52, 94208
    s_add_u32 s48, s50, 114944
    buffer_load_dwordx4 v243, s[20:23], s48 offen  lds
    s_add_u32 m0, s52, 0
    s_add_u32 s48, s50, 143616
    buffer_load_dwordx4 v243, s[20:23], s48 offen  lds
    s_add_u32 m0, s52, 4096
    s_add_u32 s48, s50, 172288
    buffer_load_dwordx4 v243, s[20:23], s48 offen  lds
    s_add_u32 m0, s52, 8192
    s_add_u32 s48, s50, 200704
    buffer_load_dwordx4 v243, s[20:23], s48 offen  lds
    s_add_u32 m0, s52, 12288
    s_add_u32 s48, s50, 229376
    buffer_load_dwordx4 v243, s[20:23], s48 offen  lds
    s_add_u32 m0, s52, 16384
    s_add_u32 s48, s50, 258048
    buffer_load_dwordx4 v243, s[20:23], s48 offen  lds
    s_add_u32 m0, s52, 20480
    s_add_u32 s48, s50, 286720
    buffer_load_dwordx4 v243, s[20:23], s48 offen  lds
    s_add_u32 m0, s52, 24576
    s_add_u32 s48, s50, 315392
    buffer_load_dwordx4 v243, s[20:23], s48 offen  lds
    s_add_u32 m0, s52, 28672
    s_add_u32 s48, s50, 344064
    buffer_load_dwordx4 v243, s[20:23], s48 offen  lds
    s_add_u32 m0, s52, 32768
    s_add_u32 s48, s50, 372736
    buffer_load_dwordx4 v243, s[20:23], s48 offen  lds
    s_waitcnt vmcnt(7)
    s_barrier
    s_add_u32 m0, s52, 65536
    s_add_u32 s48, s50, 200832
    buffer_load_dwordx4 v243, s[20:23], s48 offen  lds
    s_add_u32 m0, s52, 69632
    s_add_u32 s48, s50, 229504
    buffer_load_dwordx4 v243, s[20:23], s48 offen  lds
    s_add_u32 m0, s52, 36864
    s_add_u32 s48, s50, 286848
    buffer_load_dwordx4 v243, s[20:23], s48 offen  lds
    s_add_u32 m0, s52, 40960
    s_add_u32 s48, s50, 315520
    buffer_load_dwordx4 v243, s[20:23], s48 offen  lds
    s_add_u32 m0, s52, 45056
    s_add_u32 s48, s50, 344192
    buffer_load_dwordx4 v243, s[20:23], s48 offen  lds
    s_add_u32 m0, s52, 49152
    s_add_u32 s48, s51, 200704
    buffer_load_dwordx4 v253, s[20:23], s48 offen  lds
    s_add_u32 m0, s52, 53248
    s_add_u32 s48, s51, 258048
    buffer_load_dwordx4 v253, s[20:23], s48 offen  lds
    s_add_u32 m0, s52, 57344
    s_add_u32 s48, s51, 315392
    buffer_load_dwordx4 v253, s[20:23], s48 offen  lds
    s_add_u32 m0, s52, 61440
    s_add_u32 s48, s51, 372736
    buffer_load_dwordx4 v253, s[20:23], s48 offen  lds
    s_add_u32 m0, s52, 73728
    s_add_u32 s48, s50, 258176
    buffer_load_dwordx4 v243, s[20:23], s48 offen  lds
    s_waitcnt vmcnt(10)
    s_barrier
    s_add_u32 m0, s52, 77824
    s_add_u32 s48, s50, 372864
    buffer_load_dwordx4 v243, s[20:23], s48 offen  lds
    s_add_u32 m0, s52, 81920
    s_add_u32 s48, s50, 200960
    buffer_load_dwordx4 v243, s[20:23], s48 offen  lds
    s_add_u32 m0, s52, 86016
    s_add_u32 s48, s50, 229632
    buffer_load_dwordx4 v243, s[20:23], s48 offen  lds
    s_add_u32 m0, s52, 90112
    s_add_u32 s48, s50, 258304
    buffer_load_dwordx4 v243, s[20:23], s48 offen  lds
    s_add_u32 m0, s52, 94208
    s_add_u32 s48, s50, 286976
    buffer_load_dwordx4 v243, s[20:23], s48 offen  lds
    s_add_u32 m0, s52, 0
    s_add_u32 s48, s50, 315648
    buffer_load_dwordx4 v243, s[20:23], s48 offen  lds
    s_add_u32 m0, s52, 4096
    s_add_u32 s48, s50, 344320
    buffer_load_dwordx4 v243, s[20:23], s48 offen  lds
    s_waitcnt vmcnt(6)
    s_barrier
    s_add_u32 m0, s52, 98304
    s_add_u32 s48, s50, 372992
    buffer_load_dwordx4 v243, s[20:23], s48 offen  lds
    s_barrier
    ds_read_b128 v[0:3], v245 offset:0
    ds_read_b128 v[4:7], v245 offset:1024
    ds_read_b128 v[8:11], v245 offset:2048
    ds_read_b128 v[12:15], v245 offset:3072
    s_add_u32 s49, s53, 0
    s_waitcnt lgkmcnt(3)
    buffer_store_dwordx4 v[0:3], v240, s[24:27], s49 offen sc0 sc1 nt
    s_add_u32 s49, s53, 7168
    s_waitcnt lgkmcnt(2)
    buffer_store_dwordx4 v[4:7], v240, s[24:27], s49 offen sc0 sc1 nt
    s_add_u32 s49, s53, 14336
    s_waitcnt lgkmcnt(1)
    buffer_store_dwordx4 v[8:11], v240, s[24:27], s49 offen sc0 sc1 nt
    s_add_u32 s49, s53, 21504
    s_waitcnt lgkmcnt(0)
    buffer_store_dwordx4 v[12:15], v240, s[24:27], s49 offen sc0 sc1 nt
    s_waitcnt vmcnt(4)
    s_barrier
    ds_read_b128 v[16:19], v254 offset:0
    ds_read_b128 v[20:23], v254 offset:1024
    s_add_u32 s49, s54, 0
    s_waitcnt lgkmcnt(1)
    buffer_store_dwordx4 v[16:19], v255, s[24:27], s49 offen sc0 sc1 nt
    s_add_u32 s49, s54, 14336
    s_waitcnt lgkmcnt(0)
    buffer_store_dwordx4 v[20:23], v255, s[24:27], s49 offen sc0 sc1 nt
    s_barrier
    ds_read_b128 v[32:35], v245 offset:16384
    ds_read_b128 v[36:39], v245 offset:17408
    ds_read_b128 v[40:43], v245 offset:18432
    ds_read_b128 v[44:47], v245 offset:19456
    s_add_u32 s49, s53, 128
    s_waitcnt lgkmcnt(3)
    buffer_store_dwordx4 v[32:35], v240, s[24:27], s49 offen sc0 sc1 nt
    s_add_u32 s49, s53, 7296
    s_waitcnt lgkmcnt(2)
    buffer_store_dwordx4 v[36:39], v240, s[24:27], s49 offen sc0 sc1 nt
    s_add_u32 s49, s53, 14464
    s_waitcnt lgkmcnt(1)
    buffer_store_dwordx4 v[40:43], v240, s[24:27], s49 offen sc0 sc1 nt
    s_add_u32 s49, s53, 21632
    s_waitcnt lgkmcnt(0)
    buffer_store_dwordx4 v[44:47], v240, s[24:27], s49 offen sc0 sc1 nt
    s_barrier
    ds_read_b128 v[48:51], v245 offset:2048
    ds_read_b128 v[52:55], v245 offset:3072
    s_add_u32 s49, s53, 14592
    s_waitcnt lgkmcnt(1)
    buffer_store_dwordx4 v[48:51], v240, s[24:27], s49 offen sc0 sc1 nt
    s_add_u32 s49, s53, 21760
    s_waitcnt lgkmcnt(0)
    buffer_store_dwordx4 v[52:55], v240, s[24:27], s49 offen sc0 sc1 nt
L_end:
s_endpgm
.fill 512, 4, 0xbf800000
L_pad:
.section .rodata,"a"
.p2align 6
.amdhsa_kernel standalone__layernorm_linear__sampling_kernel
  .amdhsa_next_free_vgpr 256
  .amdhsa_next_free_sgpr 64
  .amdhsa_accum_offset 256
  .amdhsa_group_segment_fixed_size 0
  .amdhsa_kernarg_size 56
  .amdhsa_user_sgpr_count 2
  .amdhsa_user_sgpr_kernarg_segment_ptr 1
  .amdhsa_system_sgpr_workgroup_id_x 1
  .amdhsa_float_denorm_mode_32 3
  .amdhsa_float_denorm_mode_16_64 3
.end_amdhsa_kernel
```
